```python
import torch

def _softmax(x, axis=-1):
    return torch.softmax(x, dim=axis)
def _gelu(x):
    return torch.nn.functional.gelu(x, approximate="tanh")
def _silu(x):
    return torch.nn.functional.silu(x)
def _sigmoid(x):
    return torch.sigmoid(x)
def _layernorm(x, axis=-1, eps=1e-5):
    m = x.mean(dim=axis, keepdim=True)
    v = x.var(dim=axis, keepdim=True, unbiased=False)
    return (x - m) / torch.sqrt(v + eps)
def _scatter_add(tgt, idx, src, axis=0):
    return tgt.clone().index_add_(axis, idx, src)
def _segment_sum(src, seg, n):
    out = torch.zeros((n,) + src.shape[1:], dtype=src.dtype)
    return out.index_add_(0, seg, src)
def _pad(x, pw):
    flat = tuple(v for pair in reversed(pw) for v in pair)
    return torch.nn.functional.pad(x, flat)

kernel_name = 'gated_mix__sliding_block__sliding_block__prompt'

def setup_inputs():

    _w = (lambda a: (lambda t: t.to(torch.bfloat16) if t.is_floating_point() else t)(torch.as_tensor(a)))
    def _A_setup():
        B, S, D = 1, 2048, 576
        return {
            "x": _w((lambda *s: torch.randn(*s, dtype=torch.bfloat16) * 0.05)(B, S, D)),
            "wqkv": _w((lambda *s: torch.randn(*s, dtype=torch.bfloat16) * 0.8)(D, 3 * D)),
            "wo": _w((lambda *s: torch.randn(*s, dtype=torch.bfloat16) * 0.05)(D, D)),
        }
    _A_in = _A_setup()

    def _B_setup():
        B, S, D = 1, 2048, 576
        return {
            "x": _w((lambda *s: torch.randn(*s, dtype=torch.bfloat16) * 0.05)(B, S, D)),
            "wqkv": _w((lambda *s: torch.randn(*s, dtype=torch.bfloat16) * 0.8)(D, 3 * D)),
            "wo": _w((lambda *s: torch.randn(*s, dtype=torch.bfloat16) * 0.05)(D, D)),
        }
    _B_in = _B_setup()

    return {
        "A_x": _A_in["x"],
        "A_wqkv": _A_in["wqkv"],
        "A_wo": _A_in["wo"],
        "B_x": _B_in["x"],
        "B_wqkv": _B_in["wqkv"],
        "B_wo": _B_in["wo"],
        "gate_w": _w((lambda *s: torch.randn(*s, dtype=torch.bfloat16) * 0.05)(576) * 16.0),
    }

def reference(A_x, A_wqkv, A_wo, B_x, B_wqkv, B_wo, gate_w):
    def _A_ref(x, wqkv, wo):
        B, S, D = x.shape
        H = 32; Dh = D // H; W = 256
        qkv = (lambda x, *d: x.permute(*d))((x @ wqkv).reshape(B, S, 3, H, Dh), 2, 0, 3, 1, 4)
        q, k, v = qkv[0], qkv[1], qkv[2]
        scores = torch.einsum("bhqd,bhkd->bhqk", q, k) * (Dh ** -0.5)
        idx = torch.arange(S)
        mask = (idx[:, None] - idx[None, :] >= 0) & (idx[:, None] - idx[None, :] < W)
        scores = torch.where(mask[None, None], scores, -1e9)
        p = _softmax(scores, axis=-1)
        o = torch.einsum("bhqk,bhkd->bhqd", p, v)
        return (lambda x, *d: x.permute(*d))(o, 0, 2, 1, 3).reshape(B, S, D) @ wo

    def _B_ref(x, wqkv, wo):
        B, S, D = x.shape
        H = 32; Dh = D // H; W = 256
        qkv = (lambda x, *d: x.permute(*d))((x @ wqkv).reshape(B, S, 3, H, Dh), 2, 0, 3, 1, 4)
        q, k, v = qkv[0], qkv[1], qkv[2]
        scores = torch.einsum("bhqd,bhkd->bhqk", q, k) * (Dh ** -0.5)
        idx = torch.arange(S)
        mask = (idx[:, None] - idx[None, :] >= 0) & (idx[:, None] - idx[None, :] < W)
        scores = torch.where(mask[None, None], scores, -1e9)
        p = _softmax(scores, axis=-1)
        o = torch.einsum("bhqk,bhkd->bhqd", p, v)
        return (lambda x, *d: x.permute(*d))(o, 0, 2, 1, 3).reshape(B, S, D) @ wo

    x = A_x
    g = _sigmoid((x * gate_w).sum(-1, keepdims=True))
    a = _A_ref(x, A_wqkv, A_wo)
    b = _B_ref(x, B_wqkv, B_wo)
    return g * a + (1 - g) * b
```

```asm
; @launch grid=(256,1,1) block=(512,1,1) lds=161856
.amdgcn_target "amdgcn-amd-amdhsa--gfx950"
.text
.globl gated_mix__sliding_block__sliding_block__prompt_kernel
.p2align 8
.type gated_mix__sliding_block__sliding_block__prompt_kernel,@function
gated_mix__sliding_block__sliding_block__prompt_kernel:
    s_load_dwordx16 s[64:79], s[0:1], 0
    s_load_dwordx4 s[80:83], s[0:1], 64
    s_cmp_ge_u32 s2, 256
    s_cbranch_scc1 L_exit
    v_lshrrev_b32 v2, 6, v0
    v_and_b32 v1, 63, v0
    s_and_b32 s22, s2, 7
    s_lshl_b32 s22, s22, 1
    v_readfirstlane_b32 s20, v2
    s_bfe_u32 s32, s2, 0x10003
    s_add_u32 s22, s22, s32
    s_lshr_b32 s21, s2, 4
    s_mov_b32 s99, 0x40000
    s_cmp_ge_u32 s20, 4
    s_cbranch_scc1 L_loader
    s_getpc_b64 s[32:33]
L_pc_here:
    s_lshr_b32 s34, s2, 3
    s_lshl_b32 s35, s20, 5
    s_add_u32 s34, s34, s35
    s_lshl_b32 s34, s34, 7
    v_lshl_add_u32 v20, v1, 14, s34
    v_cmp_gt_u32 vcc, L_code_end-L_pc_here, v20
    s_and_saveexec_b64 s[34:35], vcc
    global_load_dword v249, v20, s[32:33]
    s_mov_b64 exec, -1
    s_branch L_compute
L_loader:
    s_setprio 3
    v_bfe_u32 v24, v0, 6, 1
    v_lshrrev_b32 v25, 4, v1
    v_lshl_or_b32 v25, v24, 2, v25
    v_and_b32 v26, 7, v1
    v_xor_b32 v25, v25, v26
    v_lshrrev_b32 v26, 3, v1
    v_mul_u32_u24 v26, 1152, v26
    v_lshl_add_u32 v31, v25, 4, v26
    v_lshrrev_b32 v25, 5, v1
    v_lshl_add_u32 v26, v24, 1, v25
    s_and_b32 s32, s20, 2
    v_lshl_or_b32 v26, v26, 2, s32
    v_and_b32 v27, 31, v1
    v_xor_b32 v27, v27, v26
    v_mul_u32_u24 v25, 216, v25
    v_mul_u32_u24 v28, 57, v27
    v_lshrrev_b32 v28, 9, v28
    v_mad_u32_u24 v25, v28, 63, v25
    v_add_lshl_u32 v32, v25, v27, 4
    v_cmp_gt_u32 s[30:31], 27, v27
    s_and_b32 s33, s20, 3
    s_lshl_b32 s26, s21, 4
    s_add_u32 s26, s26, s33
    s_mul_i32 s26, s26, 9216
    s_lshl_b32 s29, s33, 10
    s_add_u32 s33, s33, s32
    s_lshl_b32 s98, s33, 10
    s_mul_i32 s27, s33, 6912
    s_and_b32 s32, s22, 7
    s_mul_i32 s32, s32, 144
    s_add_u32 s27, s27, s32
    s_and_b32 s32, s22, 14
    s_add_u32 s25, s21, s32
    s_mul_i32 s32, s25, 57
    s_lshr_b32 s32, s32, 9
    s_mul_i32 s32, s32, 9
    s_sub_u32 s25, s25, s32
    s_mov_b32 s6, 2359296
    s_mov_b32 s7, 0x20000
    s_mov_b32 s10, 1990656
    s_mov_b32 s11, s7
    s_lshl_b32 s36, s25, 7
    s_mov_b32 m0, s29
    s_add_u32 s36, s36, s26
    s_cmp_ge_u32 s22, 8
    s_waitcnt lgkmcnt(0)
    s_mov_b64 s[4:5], s[64:65]
    s_cselect_b64 s[8:9], s[72:73], s[66:67]
    buffer_load_dwordx4 v31, s[4:7], s36 offen lds
    s_add_u32 m0, m0, 0x1000
    s_add_u32 s36, s36, 36864
    buffer_load_dwordx4 v31, s[4:7], s36 offen lds
    s_add_u32 m0, m0, 0x1000
    s_add_u32 s36, s36, 36864
    buffer_load_dwordx4 v31, s[4:7], s36 offen lds
    s_add_u32 m0, m0, 0x1000
    s_add_u32 s36, s36, 36864
    buffer_load_dwordx4 v31, s[4:7], s36 offen lds
    s_cmp_lg_u32 s20, 7
    s_cbranch_scc1 L_l_nogate
    s_mov_b64 s[16:17], s[76:77]
    s_movk_i32 s18, 1152
    s_mov_b32 s19, s7
    s_mov_b32 m0, 147456
    v_lshlrev_b32 v30, 4, v1
    buffer_load_dwordx4 v30, s[16:19], 0 offen lds
    buffer_load_dwordx4 v30, s[16:19], 0 offen offset:1024 lds
L_l_nogate:
    s_mul_i32 s37, s25, 221184
    s_add_u32 s37, s37, s27
    s_add_u32 m0, s98, 16384
    s_mov_b64 exec, s[30:31]
    buffer_load_dwordx4 v32, s[8:11], s37 offen lds
    s_add_u32 m0, m0, 2048
    s_add_u32 s37, s37, 13824
    buffer_load_dwordx4 v32, s[8:11], s37 offen lds
    s_add_u32 m0, m0, 6144
    s_add_u32 s37, s37, 41472
    buffer_load_dwordx4 v32, s[8:11], s37 offen lds
    s_add_u32 m0, m0, 2048
    s_add_u32 s37, s37, 13824
    buffer_load_dwordx4 v32, s[8:11], s37 offen lds
    s_add_u32 s37, s37, 41472
    s_mov_b64 exec, -1
    s_and_b32 s32, s2, 7
    s_lshl_b32 s32, s32, 5
    s_lshr_b32 s33, s2, 3
    s_add_u32 s32, s32, s33
    s_mul_i32 s40, s32, 7282
    s_lshr_b32 s40, s40, 16
    s_mul_i32 s41, s40, 9
    s_sub_u32 s41, s32, s41
    s_lshl_b32 s41, s41, 7
    s_cmp_lt_u32 s32, 252
    s_cselect_b32 s42, 1, 0
    s_getpc_b64 s[32:33]
L_jt_l:
    s_lshl_b32 s34, s40, 2
    s_add_u32 s34, s34, L_job_table-L_jt_l
    s_load_dword s3, s[32:33], s34
    s_add_u32 m0, s98, 32768
    s_mov_b64 exec, s[30:31]
    buffer_load_dwordx4 v32, s[8:11], s37 offen lds
    s_add_u32 m0, m0, 2048
    s_add_u32 s37, s37, 13824
    buffer_load_dwordx4 v32, s[8:11], s37 offen lds
    s_add_u32 m0, m0, 6144
    s_add_u32 s37, s37, 41472
    buffer_load_dwordx4 v32, s[8:11], s37 offen lds
    s_add_u32 m0, m0, 2048
    s_add_u32 s37, s37, 13824
    buffer_load_dwordx4 v32, s[8:11], s37 offen lds
    s_add_u32 s37, s37, 41472
    s_mov_b64 exec, -1
    v_lshlrev_b32 v33, 1, v1
    v_add_u32 v33, 147456, v33
    v_and_b32 v34, 3, v1
    v_bfe_u32 v35, v1, 3, 1
    v_lshlrev_b32 v35, 1, v35
    v_lshl_or_b32 v34, v34, 2, v35
    v_xor_b32 v34, 27, v34
    v_lshlrev_b32 v34, 4, v34
    v_lshl_add_u32 v34, v1, 9, v34
    v_add_u32 v35, 114688, v34
    v_add_u32 v34, 0x4000, v34
    s_lshl_b32 s38, s25, 7
    v_add_u32 v29, s38, v33
    s_cmp_eq_u32 s20, 7
    s_cselect_b64 s[58:59], -1, 0
    s_add_u32 s25, s25, 1
    s_cmp_eq_u32 s25, 9
    s_cselect_b32 s25, 0, s25
    s_lshl_b32 s36, s25, 7
    s_add_u32 m0, s29, 49152
    s_add_u32 s36, s36, s26
    buffer_load_dwordx4 v31, s[4:7], s36 offen lds
    s_add_u32 m0, m0, 0x1000
    s_add_u32 s36, s36, 36864
    buffer_load_dwordx4 v31, s[4:7], s36 offen lds
    s_add_u32 m0, m0, 0x1000
    s_add_u32 s36, s36, 36864
    buffer_load_dwordx4 v31, s[4:7], s36 offen lds
    s_add_u32 m0, m0, 0x1000
    s_add_u32 s36, s36, 36864
    buffer_load_dwordx4 v31, s[4:7], s36 offen lds
    s_waitcnt vmcnt(12)
    s_mov_b64 exec, s[58:59]
    ds_read_u16 v27, v29
    s_waitcnt lgkmcnt(0)
    ds_write_b16 v34, v27
    s_mov_b64 exec, -1
    s_waitcnt vmcnt(8)
    s_waitcnt lgkmcnt(0)
    s_barrier
    s_lshl_b32 s38, s25, 7
    v_add_u32 v29, s38, v33
    s_mov_b64 exec, s[58:59]
    ds_read_u16 v27, v29
    s_mul_i32 s37, s25, 221184
    s_add_u32 s37, s37, s27
    s_add_u32 m0, s98, 65536
    s_mov_b64 exec, s[30:31]
    buffer_load_dwordx4 v32, s[8:11], s37 offen lds
    s_add_u32 m0, m0, 2048
    s_add_u32 s37, s37, 13824
    buffer_load_dwordx4 v32, s[8:11], s37 offen lds
    s_add_u32 m0, m0, 6144
    s_add_u32 s37, s37, 41472
    buffer_load_dwordx4 v32, s[8:11], s37 offen lds
    s_add_u32 m0, m0, 2048
    s_add_u32 s37, s37, 13824
    buffer_load_dwordx4 v32, s[8:11], s37 offen lds
    s_add_u32 s37, s37, 41472
    s_mov_b64 exec, -1
    s_mov_b64 exec, s[58:59]
    s_waitcnt lgkmcnt(0)
    ds_write_b16 v34, v27 offset:49152
    s_mov_b64 exec, -1
    s_setprio 0
    s_mov_b32 s12, s82
    s_mov_b32 s13, s83
    s_mov_b32 s14, 268435456
    s_mov_b32 s15, 0x20000
    s_mov_b32 s48, s82
    s_mov_b32 s49, s83
    s_mov_b32 s50, 0
    s_mov_b32 s51, 0x20000
    s_mov_b32 s60, s80
    s_mov_b32 s61, s81
    s_mov_b32 s62, 256
    s_mov_b32 s63, 0x20000
    s_mov_b32 s52, s68
    s_mov_b32 s53, s69
    s_mov_b32 s54, 663552
    s_mov_b32 s55, 0x20000
    v_and_b32 v14, 31, v1
    v_lshlrev_b32_e64 v14, v14, -2
    v_lshrrev_b32 v15, 5, v1
    v_lshlrev_b32 v15, 2, v15
    v_ashrrev_i32 v14, v15, v14
    s_mov_b32 s32, 0xff800000
    v_bfe_i32 v15, v14, 0, 1
    v_and_b32 v192, s32, v15
    v_xor_b32 v208, s32, v192
    v_bfe_i32 v15, v14, 1, 1
    v_and_b32 v193, s32, v15
    v_xor_b32 v209, s32, v193
    v_bfe_i32 v15, v14, 2, 1
    v_and_b32 v194, s32, v15
    v_xor_b32 v210, s32, v194
    v_bfe_i32 v15, v14, 3, 1
    v_and_b32 v195, s32, v15
    v_xor_b32 v211, s32, v195
    v_bfe_i32 v15, v14, 8, 1
    v_and_b32 v196, s32, v15
    v_xor_b32 v212, s32, v196
    v_bfe_i32 v15, v14, 9, 1
    v_and_b32 v197, s32, v15
    v_xor_b32 v213, s32, v197
    v_bfe_i32 v15, v14, 10, 1
    v_and_b32 v198, s32, v15
    v_xor_b32 v214, s32, v198
    v_bfe_i32 v15, v14, 11, 1
    v_and_b32 v199, s32, v15
    v_xor_b32 v215, s32, v199
    s_setprio 3
    s_waitcnt vmcnt(8)
    s_waitcnt lgkmcnt(0)
    s_barrier
    s_add_u32 m0, s98, 81920
    s_mov_b64 exec, s[30:31]
    buffer_load_dwordx4 v32, s[8:11], s37 offen lds
    s_add_u32 m0, m0, 2048
    s_add_u32 s37, s37, 13824
    buffer_load_dwordx4 v32, s[8:11], s37 offen lds
    s_add_u32 m0, m0, 6144
    s_add_u32 s37, s37, 41472
    buffer_load_dwordx4 v32, s[8:11], s37 offen lds
    s_add_u32 m0, m0, 2048
    s_add_u32 s37, s37, 13824
    buffer_load_dwordx4 v32, s[8:11], s37 offen lds
    s_add_u32 s37, s37, 41472
    s_mov_b64 exec, -1
    s_add_u32 s25, s25, 1
    s_cmp_eq_u32 s25, 9
    s_cselect_b32 s25, 0, s25
    s_lshl_b32 s36, s25, 7
    s_add_u32 m0, s29, 98304
    s_add_u32 s36, s36, s26
    buffer_load_dwordx4 v31, s[4:7], s36 offen lds
    s_add_u32 m0, m0, 0x1000
    s_add_u32 s36, s36, 36864
    buffer_load_dwordx4 v31, s[4:7], s36 offen lds
    s_add_u32 m0, m0, 0x1000
    s_add_u32 s36, s36, 36864
    buffer_load_dwordx4 v31, s[4:7], s36 offen lds
    s_add_u32 m0, m0, 0x1000
    s_add_u32 s36, s36, 36864
    buffer_load_dwordx4 v31, s[4:7], s36 offen lds
    s_setprio 0
    v_bfe_i32 v15, v14, 16, 1
    v_and_b32 v200, s32, v15
    v_xor_b32 v216, s32, v200
    v_bfe_i32 v15, v14, 17, 1
    v_and_b32 v201, s32, v15
    v_xor_b32 v217, s32, v201
    v_bfe_i32 v15, v14, 18, 1
    v_and_b32 v202, s32, v15
    v_xor_b32 v218, s32, v202
    v_bfe_i32 v15, v14, 19, 1
    v_and_b32 v203, s32, v15
    v_xor_b32 v219, s32, v203
    v_bfe_i32 v15, v14, 24, 1
    v_and_b32 v204, s32, v15
    v_xor_b32 v220, s32, v204
    v_bfe_i32 v15, v14, 25, 1
    v_and_b32 v205, s32, v15
    v_xor_b32 v221, s32, v205
    v_bfe_i32 v15, v14, 26, 1
    v_and_b32 v206, s32, v15
    v_xor_b32 v222, s32, v206
    v_bfe_i32 v15, v14, 27, 1
    v_and_b32 v207, s32, v15
    s_setprio 3
    s_waitcnt vmcnt(8)
    s_waitcnt lgkmcnt(0)
    s_barrier
    s_lshl_b32 s38, s25, 7
    v_add_u32 v29, s38, v33
    s_mov_b64 exec, s[58:59]
    ds_read_u16 v27, v29
    s_mul_i32 s37, s25, 221184
    s_add_u32 s37, s37, s27
    s_add_u32 m0, s98, 114688
    s_mov_b64 exec, s[30:31]
    buffer_load_dwordx4 v32, s[8:11], s37 offen lds
    s_add_u32 m0, m0, 2048
    s_add_u32 s37, s37, 13824
    buffer_load_dwordx4 v32, s[8:11], s37 offen lds
    s_add_u32 m0, m0, 6144
    s_add_u32 s37, s37, 41472
    buffer_load_dwordx4 v32, s[8:11], s37 offen lds
    s_add_u32 m0, m0, 2048
    s_add_u32 s37, s37, 13824
    buffer_load_dwordx4 v32, s[8:11], s37 offen lds
    s_add_u32 s37, s37, 41472
    s_mov_b64 exec, -1
    s_mov_b64 exec, s[58:59]
    s_waitcnt lgkmcnt(0)
    ds_write_b16 v35, v27
    s_mov_b64 exec, -1
    s_waitcnt vmcnt(8)
    s_waitcnt lgkmcnt(0)
    s_barrier
    s_add_u32 m0, s98, 131072
    s_mov_b64 exec, s[30:31]
    buffer_load_dwordx4 v32, s[8:11], s37 offen lds
    s_add_u32 m0, m0, 2048
    s_add_u32 s37, s37, 13824
    buffer_load_dwordx4 v32, s[8:11], s37 offen lds
    s_add_u32 m0, m0, 6144
    s_add_u32 s37, s37, 41472
    buffer_load_dwordx4 v32, s[8:11], s37 offen lds
    s_add_u32 m0, m0, 2048
    s_add_u32 s37, s37, 13824
    buffer_load_dwordx4 v32, s[8:11], s37 offen lds
    s_add_u32 s37, s37, 41472
    s_mov_b64 exec, -1
    s_add_u32 s25, s25, 1
    s_cmp_eq_u32 s25, 9
    s_cselect_b32 s25, 0, s25
    s_lshl_b32 s36, s25, 7
    s_add_u32 m0, s29, 0
    s_add_u32 s36, s36, s26
    buffer_load_dwordx4 v31, s[4:7], s36 offen lds
    s_add_u32 m0, m0, 0x1000
    s_add_u32 s36, s36, 36864
    buffer_load_dwordx4 v31, s[4:7], s36 offen lds
    s_add_u32 m0, m0, 0x1000
    s_add_u32 s36, s36, 36864
    buffer_load_dwordx4 v31, s[4:7], s36 offen lds
    s_add_u32 m0, m0, 0x1000
    s_add_u32 s36, s36, 36864
    buffer_load_dwordx4 v31, s[4:7], s36 offen lds
    s_waitcnt vmcnt(8)
    s_waitcnt lgkmcnt(0)
    s_barrier
    s_lshl_b32 s38, s25, 7
    v_add_u32 v29, s38, v33
    s_mov_b64 exec, s[58:59]
    ds_read_u16 v27, v29
    s_mul_i32 s37, s25, 221184
    s_add_u32 s37, s37, s27
    s_add_u32 m0, s98, 16384
    s_mov_b64 exec, s[30:31]
    buffer_load_dwordx4 v32, s[8:11], s37 offen lds
    s_add_u32 m0, m0, 2048
    s_add_u32 s37, s37, 13824
    buffer_load_dwordx4 v32, s[8:11], s37 offen lds
    s_add_u32 m0, m0, 6144
    s_add_u32 s37, s37, 41472
    buffer_load_dwordx4 v32, s[8:11], s37 offen lds
    s_add_u32 m0, m0, 2048
    s_add_u32 s37, s37, 13824
    buffer_load_dwordx4 v32, s[8:11], s37 offen lds
    s_add_u32 s37, s37, 41472
    s_mov_b64 exec, -1
    s_mov_b64 exec, s[58:59]
    s_waitcnt lgkmcnt(0)
    ds_write_b16 v34, v27
    s_mov_b64 exec, -1
    s_waitcnt vmcnt(8)
    s_waitcnt lgkmcnt(0)
    s_barrier
    s_add_u32 m0, s98, 32768
    s_mov_b64 exec, s[30:31]
    buffer_load_dwordx4 v32, s[8:11], s37 offen lds
    s_add_u32 m0, m0, 2048
    s_add_u32 s37, s37, 13824
    buffer_load_dwordx4 v32, s[8:11], s37 offen lds
    s_add_u32 m0, m0, 6144
    s_add_u32 s37, s37, 41472
    buffer_load_dwordx4 v32, s[8:11], s37 offen lds
    s_add_u32 m0, m0, 2048
    s_add_u32 s37, s37, 13824
    buffer_load_dwordx4 v32, s[8:11], s37 offen lds
    s_add_u32 s37, s37, 41472
    s_mov_b64 exec, -1
    s_add_u32 s25, s25, 1
    s_cmp_eq_u32 s25, 9
    s_cselect_b32 s25, 0, s25
    s_lshl_b32 s36, s25, 7
    s_add_u32 m0, s29, 49152
    s_add_u32 s36, s36, s26
    buffer_load_dwordx4 v31, s[4:7], s36 offen lds
    s_add_u32 m0, m0, 0x1000
    s_add_u32 s36, s36, 36864
    buffer_load_dwordx4 v31, s[4:7], s36 offen lds
    s_add_u32 m0, m0, 0x1000
    s_add_u32 s36, s36, 36864
    buffer_load_dwordx4 v31, s[4:7], s36 offen lds
    s_add_u32 m0, m0, 0x1000
    s_add_u32 s36, s36, 36864
    buffer_load_dwordx4 v31, s[4:7], s36 offen lds
    s_waitcnt vmcnt(8)
    s_waitcnt lgkmcnt(0)
    s_barrier
    s_lshl_b32 s38, s25, 7
    v_add_u32 v29, s38, v33
    s_mov_b64 exec, s[58:59]
    ds_read_u16 v27, v29
    s_mul_i32 s37, s25, 221184
    s_add_u32 s37, s37, s27
    s_add_u32 m0, s98, 65536
    s_mov_b64 exec, s[30:31]
    buffer_load_dwordx4 v32, s[8:11], s37 offen lds
    s_add_u32 m0, m0, 2048
    s_add_u32 s37, s37, 13824
    buffer_load_dwordx4 v32, s[8:11], s37 offen lds
    s_add_u32 m0, m0, 6144
    s_add_u32 s37, s37, 41472
    buffer_load_dwordx4 v32, s[8:11], s37 offen lds
    s_add_u32 m0, m0, 2048
    s_add_u32 s37, s37, 13824
    buffer_load_dwordx4 v32, s[8:11], s37 offen lds
    s_add_u32 s37, s37, 41472
    s_mov_b64 exec, -1
    s_mov_b64 exec, s[58:59]
    s_waitcnt lgkmcnt(0)
    ds_write_b16 v34, v27 offset:49152
    s_mov_b64 exec, -1
    s_waitcnt vmcnt(8)
    s_waitcnt lgkmcnt(0)
    s_barrier
    s_add_u32 m0, s98, 81920
    s_mov_b64 exec, s[30:31]
    buffer_load_dwordx4 v32, s[8:11], s37 offen lds
    s_add_u32 m0, m0, 2048
    s_add_u32 s37, s37, 13824
    buffer_load_dwordx4 v32, s[8:11], s37 offen lds
    s_add_u32 m0, m0, 6144
    s_add_u32 s37, s37, 41472
    buffer_load_dwordx4 v32, s[8:11], s37 offen lds
    s_add_u32 m0, m0, 2048
    s_add_u32 s37, s37, 13824
    buffer_load_dwordx4 v32, s[8:11], s37 offen lds
    s_add_u32 s37, s37, 41472
    s_mov_b64 exec, -1
    s_bitcmp1_b32 s20, 1
    s_cselect_b32 s52, s74, s68
    s_cselect_b32 s53, s75, s69
    s_mov_b32 s54, 663552
    s_mov_b32 s55, s7
    s_lshl_b32 s36, s2, 1
    s_and_b32 s38, s20, 1
    s_add_u32 s36, s36, s38
    s_mul_i32 s36, s36, 1408
    v_lshlrev_b32 v28, 7, v1
    s_mov_b64 exec, 0x7ff
    buffer_load_dword v63, v28, s[52:55], s36 offen
    s_mov_b64 exec, -1
    s_mov_b64 exec, 1
    buffer_load_dword v26, off, s[60:63], 0 sc1
    s_mov_b64 exec, -1
    s_add_u32 s25, s25, 1
    s_cmp_eq_u32 s25, 9
    s_cselect_b32 s25, 0, s25
    s_lshl_b32 s36, s25, 7
    s_add_u32 m0, s29, 98304
    s_add_u32 s36, s36, s26
    buffer_load_dwordx4 v31, s[4:7], s36 offen lds
    s_add_u32 m0, m0, 0x1000
    s_add_u32 s36, s36, 36864
    buffer_load_dwordx4 v31, s[4:7], s36 offen lds
    s_add_u32 m0, m0, 0x1000
    s_add_u32 s36, s36, 36864
    buffer_load_dwordx4 v31, s[4:7], s36 offen lds
    s_add_u32 m0, m0, 0x1000
    s_add_u32 s36, s36, 36864
    buffer_load_dwordx4 v31, s[4:7], s36 offen lds
    s_waitcnt vmcnt(10)
    s_waitcnt lgkmcnt(0)
    s_barrier
    s_lshl_b32 s38, s25, 7
    v_add_u32 v29, s38, v33
    s_mov_b64 exec, s[58:59]
    ds_read_u16 v27, v29
    s_mul_i32 s37, s25, 221184
    s_add_u32 s37, s37, s27
    s_add_u32 m0, s98, 114688
    s_mov_b64 exec, s[30:31]
    buffer_load_dwordx4 v32, s[8:11], s37 offen lds
    s_add_u32 m0, m0, 2048
    s_add_u32 s37, s37, 13824
    buffer_load_dwordx4 v32, s[8:11], s37 offen lds
    s_add_u32 m0, m0, 6144
    s_add_u32 s37, s37, 41472
    buffer_load_dwordx4 v32, s[8:11], s37 offen lds
    s_add_u32 m0, m0, 2048
    s_add_u32 s37, s37, 13824
    buffer_load_dwordx4 v32, s[8:11], s37 offen lds
    s_add_u32 s37, s37, 41472
    s_mov_b64 exec, -1
    s_mov_b64 exec, s[58:59]
    s_waitcnt lgkmcnt(0)
    ds_write_b16 v35, v27
    s_mov_b64 exec, -1
    s_waitcnt vmcnt(10)
    s_waitcnt lgkmcnt(0)
    s_barrier
    s_add_u32 m0, s98, 131072
    s_mov_b64 exec, s[30:31]
    buffer_load_dwordx4 v32, s[8:11], s37 offen lds
    s_add_u32 m0, m0, 2048
    s_add_u32 s37, s37, 13824
    buffer_load_dwordx4 v32, s[8:11], s37 offen lds
    s_add_u32 m0, m0, 6144
    s_add_u32 s37, s37, 41472
    buffer_load_dwordx4 v32, s[8:11], s37 offen lds
    s_add_u32 m0, m0, 2048
    s_add_u32 s37, s37, 13824
    buffer_load_dwordx4 v32, s[8:11], s37 offen lds
    s_add_u32 s37, s37, 41472
    s_mov_b64 exec, -1
    s_waitcnt vmcnt(12)
L_tag1:
    v_readfirstlane_b32 s23, v26
    s_cmp_lg_u32 s23, 0
    s_cbranch_scc1 L_tag1_ok
    s_sub_u32 s99, s99, 1
    s_cbranch_scc1 L_tag1_ok
    s_sleep 2
    s_mov_b64 exec, 1
    buffer_load_dword v26, off, s[60:63], 0 sc1
    s_mov_b64 exec, -1
    s_waitcnt vmcnt(0)
    s_branch L_tag1
L_tag1_ok:
    s_getreg_b32 s24, hwreg(HW_REG_XCC_ID, 0, 3)
    s_or_b32 s24, s24, s23
    s_lshl_b32 s28, s2, 7
    s_add_u32 s28, s28, 25362432
    v_mov_b32 v26, s24
    s_andn2_b32 s38, 268435456, s58
    s_add_u32 s38, s38, s28
    s_mov_b64 exec, 1
    buffer_store_dword v26, off, s[12:15], s38 sc1
    s_mov_b64 exec, -1
    s_add_u32 s25, s25, 1
    s_cmp_eq_u32 s25, 9
    s_cselect_b32 s25, 0, s25
    s_lshl_b32 s36, s25, 7
    s_add_u32 m0, s29, 0
    s_add_u32 s36, s36, s26
    buffer_load_dwordx4 v31, s[4:7], s36 offen lds
    s_add_u32 m0, m0, 0x1000
    s_add_u32 s36, s36, 36864
    buffer_load_dwordx4 v31, s[4:7], s36 offen lds
    s_add_u32 m0, m0, 0x1000
    s_add_u32 s36, s36, 36864
    buffer_load_dwordx4 v31, s[4:7], s36 offen lds
    s_add_u32 m0, m0, 0x1000
    s_add_u32 s36, s36, 36864
    buffer_load_dwordx4 v31, s[4:7], s36 offen lds
    s_waitcnt vmcnt(9)
    s_waitcnt lgkmcnt(0)
    s_barrier
    s_lshl_b32 s38, s25, 7
    v_add_u32 v29, s38, v33
    s_mov_b64 exec, s[58:59]
    ds_read_u16 v27, v29
    s_mul_i32 s37, s25, 221184
    s_add_u32 s37, s37, s27
    s_add_u32 m0, s98, 16384
    s_mov_b64 exec, s[30:31]
    buffer_load_dwordx4 v32, s[8:11], s37 offen lds
    s_add_u32 m0, m0, 2048
    s_add_u32 s37, s37, 13824
    buffer_load_dwordx4 v32, s[8:11], s37 offen lds
    s_add_u32 m0, m0, 6144
    s_add_u32 s37, s37, 41472
    buffer_load_dwordx4 v32, s[8:11], s37 offen lds
    s_add_u32 m0, m0, 2048
    s_add_u32 s37, s37, 13824
    buffer_load_dwordx4 v32, s[8:11], s37 offen lds
    s_add_u32 s37, s37, 41472
    s_mov_b64 exec, -1
    s_mov_b64 exec, s[58:59]
    s_waitcnt lgkmcnt(0)
    ds_write_b16 v34, v27
    s_mov_b64 exec, -1
    s_branch L_epi_cross_pad
L_epi_cross_ret:
    s_waitcnt vmcnt(9)
    s_waitcnt lgkmcnt(0)
    s_barrier
    s_add_u32 m0, s98, 32768
    s_mov_b64 exec, s[30:31]
    buffer_load_dwordx4 v32, s[8:11], s37 offen lds
    s_add_u32 m0, m0, 2048
    s_add_u32 s37, s37, 13824
    buffer_load_dwordx4 v32, s[8:11], s37 offen lds
    s_add_u32 m0, m0, 6144
    s_add_u32 s37, s37, 41472
    buffer_load_dwordx4 v32, s[8:11], s37 offen lds
    s_add_u32 m0, m0, 2048
    s_add_u32 s37, s37, 13824
    buffer_load_dwordx4 v32, s[8:11], s37 offen lds
    s_add_u32 s37, s37, 41472
    s_mov_b64 exec, -1
    s_add_u32 s25, s25, 1
    s_cmp_eq_u32 s25, 9
    s_cselect_b32 s25, 0, s25
    s_lshl_b32 s36, s25, 7
    s_add_u32 m0, s29, 49152
    s_add_u32 s36, s36, s26
    buffer_load_dwordx4 v31, s[4:7], s36 offen lds
    s_add_u32 m0, m0, 0x1000
    s_add_u32 s36, s36, 36864
    buffer_load_dwordx4 v31, s[4:7], s36 offen lds
    s_add_u32 m0, m0, 0x1000
    s_add_u32 s36, s36, 36864
    buffer_load_dwordx4 v31, s[4:7], s36 offen lds
    s_add_u32 m0, m0, 0x1000
    s_add_u32 s36, s36, 36864
    buffer_load_dwordx4 v31, s[4:7], s36 offen lds
    s_waitcnt vmcnt(8)
    s_waitcnt lgkmcnt(0)
    s_barrier
    s_lshl_b32 s38, s25, 7
    v_add_u32 v29, s38, v33
    s_mov_b64 exec, s[58:59]
    ds_read_u16 v27, v29
    s_mul_i32 s37, s25, 221184
    s_add_u32 s37, s37, s27
    s_add_u32 m0, s98, 65536
    s_mov_b64 exec, s[30:31]
    buffer_load_dwordx4 v32, s[8:11], s37 offen lds
    s_add_u32 m0, m0, 2048
    s_add_u32 s37, s37, 13824
    buffer_load_dwordx4 v32, s[8:11], s37 offen lds
    s_add_u32 m0, m0, 6144
    s_add_u32 s37, s37, 41472
    buffer_load_dwordx4 v32, s[8:11], s37 offen lds
    s_add_u32 m0, m0, 2048
    s_add_u32 s37, s37, 13824
    buffer_load_dwordx4 v32, s[8:11], s37 offen lds
    s_add_u32 s37, s37, 41472
    s_mov_b64 exec, -1
    s_mov_b64 exec, s[58:59]
    s_waitcnt lgkmcnt(0)
    ds_write_b16 v34, v27 offset:49152
    s_mov_b64 exec, -1
    s_branch L_attn_pad
L_attn_ret:
    s_waitcnt vmcnt(8)
    s_waitcnt lgkmcnt(0)
    s_barrier
    s_add_u32 m0, s98, 81920
    s_mov_b64 exec, s[30:31]
    buffer_load_dwordx4 v32, s[8:11], s37 offen lds
    s_add_u32 m0, m0, 2048
    s_add_u32 s37, s37, 13824
    buffer_load_dwordx4 v32, s[8:11], s37 offen lds
    s_add_u32 m0, m0, 6144
    s_add_u32 s37, s37, 41472
    buffer_load_dwordx4 v32, s[8:11], s37 offen lds
    s_add_u32 m0, m0, 2048
    s_add_u32 s37, s37, 13824
    buffer_load_dwordx4 v32, s[8:11], s37 offen lds
    s_add_u32 s37, s37, 41472
    s_mov_b64 exec, -1
    v_lshlrev_b32 v25, 11, v1
    s_mov_b64 exec, 3
    buffer_load_dword v26, v25, s[12:15], s28 offen offset:2048 sc1
    s_mov_b64 exec, -1
    s_add_u32 s25, s25, 1
    s_cmp_eq_u32 s25, 9
    s_cselect_b32 s25, 0, s25
    s_lshl_b32 s36, s25, 7
    s_add_u32 m0, s29, 98304
    s_add_u32 s36, s36, s26
    buffer_load_dwordx4 v31, s[4:7], s36 offen lds
    s_add_u32 m0, m0, 0x1000
    s_add_u32 s36, s36, 36864
    buffer_load_dwordx4 v31, s[4:7], s36 offen lds
    s_add_u32 m0, m0, 0x1000
    s_add_u32 s36, s36, 36864
    buffer_load_dwordx4 v31, s[4:7], s36 offen lds
    s_add_u32 m0, m0, 0x1000
    s_add_u32 s36, s36, 36864
    buffer_load_dwordx4 v31, s[4:7], s36 offen lds
    s_waitcnt vmcnt(9)
    s_waitcnt lgkmcnt(0)
    s_barrier
    s_lshl_b32 s38, s25, 7
    v_add_u32 v29, s38, v33
    s_mov_b64 exec, s[58:59]
    ds_read_u16 v27, v29
    s_mul_i32 s37, s25, 221184
    s_add_u32 s37, s37, s27
    s_add_u32 m0, s98, 114688
    s_mov_b64 exec, s[30:31]
    buffer_load_dwordx4 v32, s[8:11], s37 offen lds
    s_add_u32 m0, m0, 2048
    s_add_u32 s37, s37, 13824
    buffer_load_dwordx4 v32, s[8:11], s37 offen lds
    s_add_u32 m0, m0, 6144
    s_add_u32 s37, s37, 41472
    buffer_load_dwordx4 v32, s[8:11], s37 offen lds
    s_add_u32 m0, m0, 2048
    s_add_u32 s37, s37, 13824
    buffer_load_dwordx4 v32, s[8:11], s37 offen lds
    s_add_u32 s37, s37, 41472
    s_mov_b64 exec, -1
    s_mov_b64 exec, s[58:59]
    s_waitcnt lgkmcnt(0)
    ds_write_b16 v35, v27
    s_mov_b64 exec, -1
    s_branch L_hook7_pad
L_hook7_ret:
    s_waitcnt vmcnt(9)
    s_waitcnt lgkmcnt(0)
    s_barrier
    s_add_u32 m0, s98, 131072
    s_mov_b64 exec, s[30:31]
    buffer_load_dwordx4 v32, s[8:11], s37 offen lds
    s_add_u32 m0, m0, 2048
    s_add_u32 s37, s37, 13824
    buffer_load_dwordx4 v32, s[8:11], s37 offen lds
    s_add_u32 m0, m0, 6144
    s_add_u32 s37, s37, 41472
    buffer_load_dwordx4 v32, s[8:11], s37 offen lds
    s_add_u32 m0, m0, 2048
    s_add_u32 s37, s37, 13824
    buffer_load_dwordx4 v32, s[8:11], s37 offen lds
    s_add_u32 s37, s37, 41472
    s_mov_b64 exec, -1
    s_waitcnt vmcnt(4)
    s_waitcnt lgkmcnt(0)
    s_barrier
    s_lshl_b32 s38, s22, 4
    s_add_u32 s38, s38, s21
    s_lshl_b32 s36, s38, 2
    s_add_u32 s36, s36, s20
    s_mul_i32 s36, s36, 9728
    v_lshlrev_b32 v28, 7, v1
    s_sub_u32 s36, s36, 34048
    s_mov_b32 exec_hi, 63
    s_mov_b32 exec_lo, -1
    buffer_load_dword v62, v28, s[12:15], s36 offen
    s_lshl_b32 s38, s38, 7
    s_add_u32 s38, s38, 25165824
    s_mov_b64 exec, 1
    buffer_load_dword v63, off, s[12:15], s38
    s_mov_b64 exec, -1
L_tag_check:
    v_readlane_b32 s36, v26, 0
    v_readlane_b32 s38, v26, 1
    s_cmp_ge_u32 s21, 15
    s_cselect_b32 s36, s24, s36
    s_cmp_ge_u32 s21, 14
    s_cselect_b32 s38, s24, s38
    s_xor_b32 s36, s36, s24
    s_xor_b32 s38, s38, s24
    s_or_b32 s36, s36, s38
    s_cmp_lt_u32 s36, 8
    s_cbranch_scc1 L_tag_ok
    s_sub_u32 s99, s99, 1
    s_cbranch_scc1 L_tag_ok
    s_sleep 2
    s_mov_b64 exec, 3
    buffer_load_dword v26, v25, s[12:15], s28 offen offset:2048 sc1
    s_mov_b64 exec, -1
    s_waitcnt vmcnt(0)
    s_branch L_tag_check
L_tag_ok:
    v_mov_b32 v36, s23
    v_mov_b32 v37, s36
    v_mov_b32 v30, 151552
    v_mov_b64 v[40:41], 0
    v_mov_b64 v[42:43], 0
    s_and_b64 exec, s[58:59], 1
    ds_write_b64 v30, v[36:37]
    ds_write_b128 v30, v[40:43] offset:16
    ds_write_b128 v30, v[40:43] offset:32
    s_mov_b64 exec, -1
    s_waitcnt vmcnt(2)
    s_waitcnt lgkmcnt(0)
    s_barrier
    s_barrier
    s_setprio 0
    v_xor_b32 v223, s32, v207
    s_and_b32 s45, s20, 3
    s_cmp_lt_u32 s20, 4
    s_cselect_b32 s46, 2, 0
    s_mul_i32 s43, s45, 29184
    s_mul_i32 s32, s46, 2432
    s_add_u32 s32, s32, s43
    v_lshlrev_b32 v185, 4, v1
    v_and_b32 v186, 31, v1
    v_lshlrev_b32 v186, 2, v186
    s_lshl_b32 s33, s45, 2
    s_add_u32 s33, s33, s46
    s_lshl_b32 s34, s33, 10
    s_add_u32 s34, s34, 116736
    v_add_u32 v182, s34, v185
    s_lshl_b32 s34, s33, 7
    s_add_u32 s34, s34, 133120
    v_add_u32 v183, s34, v186
    s_lshl_b32 s34, s46, 7
    s_add_u32 s34, s34, 135168
    v_add_u32 v184, s34, v186
    v_add_u32 v176, s32, v185
    v_add_u32 v177, s32, v186
    v_lshrrev_b32 v14, 5, v1
    v_bfe_u32 v15, v1, 2, 2
    v_bfe_u32 v16, v1, 1, 1
    v_xor_b32 v17, v14, v16
    v_lshl_add_u32 v17, v17, 2, v15
    v_lshlrev_b32 v17, 4, v17
    v_lshl_add_u32 v17, v16, 9, v17
    v_and_b32 v16, 1, v1
    v_lshl_add_u32 v17, v16, 3, v17
    v_lshlrev_b32 v15, 3, v15
    v_lshl_add_u32 v15, v14, 5, v15
    v_and_b32 v16, 16, v1
    v_cmp_ne_u32 vcc, 0, v16
    v_add_u32 v17, s32, v17
    v_add_u32 v15, s32, v15
    v_add_u32 v18, 0, v17
    v_add_u32 v19, 1152, v15
    v_cndmask_b32 v178, v18, v19, vcc
    v_add_u32 v18, 128, v17
    v_add_u32 v19, 1024, v15
    v_cndmask_b32 v179, v18, v19, vcc
    v_add_u32 v18, 256, v17
    v_add_u32 v19, 1216, v15
    v_cndmask_b32 v180, v18, v19, vcc
    v_add_u32 v18, 384, v17
    v_add_u32 v19, 1088, v15
    v_cndmask_b32 v181, v18, v19, vcc
    v_subrev_u32 v187, 1, v14
    s_lshl_b32 s32, s21, 2
    s_add_u32 s32, s32, s46
    s_mul_i32 s32, s32, 72
    s_lshl_b32 s33, s22, 1
    s_add_u32 s32, s32, s33
    s_lshr_b32 s33, s45, 1
    s_add_u32 s32, s32, s33
    s_lshl_b32 s32, s32, 10
    s_and_b32 s33, s45, 1
    s_lshl_b32 s33, s33, 9
    s_add_u32 s32, s32, s33
    s_add_u32 s56, s32, 16777216
    s_add_u32 s57, s56, 73728
    v_and_b32 v15, 15, v1
    v_lshlrev_b32 v15, 4, v15
    v_lshl_add_u32 v15, v14, 8, v15
    v_bfe_u32 v16, v1, 4, 1
    v_mul_u32_u24 v16, 36864, v16
    v_add_u32 v188, v15, v16
    s_lshl_b32 s33, s46, 9
    s_lshl_b32 s34, s45, 2
    s_add_u32 s33, s33, s34
    s_add_u32 s33, s33, 149504
    v_lshl_add_u32 v189, v186, 2, s33
    s_lshl_b32 s32, s22, 4
    s_add_u32 s32, s32, s21
    s_mul_i32 s44, s32, 38912
    s_lshl_b32 s47, s21, 2
    s_add_u32 s47, s47, s46
    s_sub_u32 s47, 8, s47
    v_lshrrev_b32 v3, 4, v1
    v_and_b32 v2, 15, v1
    v_mul_u32_u24 v163, 36864, v3
    v_lshl_add_u32 v163, v2, 4, v163
    v_mov_b32 v160, 151576
    v_mov_b32 v161, 1
    v_add_u32 v162, 149504, v185
    v_mov_b32 v5, v185
    v_lshrrev_b32 v3, 4, v1
    v_and_b32 v2, 15, v1
    v_mul_u32_u24 v6, 1152, v3
    v_lshl_add_u32 v6, v2, 3, v6
    v_lshrrev_b32 v4, 4, v0
    v_mul_u32_u24 v4, 272, v4
    v_lshl_add_u32 v4, v2, 4, v4
    v_and_b32 v3, 7, v1
    v_bfe_u32 v22, v0, 3, 5
    v_mul_u32_u24 v8, 272, v22
    v_lshl_add_u32 v8, v3, 5, v8
    v_add_u32 v11, 116736, v8
    v_add_u32 v8, 19456, v8
    v_add_u32 v9, 58368, v8
    v_lshrrev_b32 v22, 3, v1
    v_mul_u32_u24 v10, 1152, v22
    v_lshl_add_u32 v10, v3, 4, v10
    v_mov_b32 v20, 0
    v_and_b32 v3, 7, v1
    v_lshrrev_b32 v22, 3, v1
    v_mul_u32_u24 v22, 1152, v22
    v_bfe_u32 v21, v1, 4, 1
    v_lshlrev_b32 v21, 1, v21
    v_xor_b32 v21, v21, v3
    v_lshl_add_u32 v16, v21, 4, v22
    v_xor_b32 v17, 64, v16
    v_lshrrev_b32 v18, 5, v1
    v_mul_u32_u24 v18, 36864, v18
    v_add_u32 v18, v18, v16
    v_xor_b32 v19, 64, v18
    s_lshl_b32 s32, s45, 2
    s_add_u32 s32, s32, 151584
    v_mov_b32 v168, s32
    s_lshl_b32 s94, s45, 13
    s_add_u32 s93, s94, 116736
    s_and_b32 s73, s45, 1
    s_mul_i32 s73, s73, 331776
    s_add_u32 s73, s73, s41
    s_lshr_b32 s35, s40, 1
    s_add_u32 s35, s35, 2
    s_lshl_b32 s39, s35, 2
    s_and_b32 s33, s40, 1
    s_add_u32 s39, s39, s33
    s_and_b32 s33, s20, 1
    s_and_b32 s32, s20, 2
    s_lshl_b32 s32, s32, 2
    s_lshr_b32 s32, s3, s32
    s_and_b32 s32, s32, 0xff
    s_lshl_b32 s32, s32, 1
    s_add_u32 s32, s32, s33
    s_mul_i32 s67, s32, 9216
    s_add_u32 s67, s67, s41
    s_bfe_u32 s32, s3, 0x80010
    s_lshl_b32 s32, s32, 1
    s_add_u32 s32, s32, s33
    s_mul_i32 s70, s32, 9216
    s_add_u32 s70, s70, s41
    s_lshl_b32 s32, s39, 3
    s_add_u32 s32, s32, s20
    s_mul_i32 s91, s32, 4608
    s_add_u32 s91, s91, s41
    s_lshl_b32 s71, s21, 4
    s_add_u32 s71, s71, s22
    s_lshl_b32 s71, s71, 7
    s_add_u32 s71, s71, 25264128
    s_mul_i32 s32, s21, 294912
    s_lshl_b32 s33, s22, 8
    s_add_u32 s32, s32, s33
    s_add_u32 s72, s32, 16809984
    s_mov_b32 s16, s78
    s_mov_b32 s17, s79
    s_mov_b32 s18, 2359296
    s_mov_b32 s19, 0x20000
    s_mov_b32 s3, 1
    s_setprio 1
    s_barrier
    s_branch L_attn
L_compute:
    s_and_b32 s32, s2, 7
    s_lshl_b32 s32, s32, 5
    s_lshr_b32 s33, s2, 3
    s_add_u32 s32, s32, s33
    s_mul_i32 s40, s32, 7282
    s_lshr_b32 s40, s40, 16
    s_mul_i32 s41, s40, 9
    s_sub_u32 s41, s32, s41
    s_lshl_b32 s41, s41, 7
    s_cmp_lt_u32 s32, 252
    s_cselect_b32 s42, 1, 0
    s_getpc_b64 s[32:33]
L_jt_c:
    s_lshl_b32 s34, s40, 2
    s_add_u32 s34, s34, L_job_table-L_jt_c
    s_load_dword s3, s[32:33], s34
    s_and_b32 s27, s20, 1
    s_lshr_b32 s26, s20, 1
    s_lshl_b32 s32, s27, 13
    v_and_b32 v14, 15, v1
    v_lshrrev_b32 v15, 4, v1
    v_bfe_u32 v16, v1, 1, 3
    v_xor_b32 v16, v16, v15
    v_lshlrev_b32 v16, 4, v16
    v_lshl_add_u32 v16, v14, 7, v16
    v_add_u32 v2, s32, v16
    v_xor_b32 v3, 64, v2
    v_bfe_u32 v16, v1, 2, 2
    v_lshl_add_u32 v17, v15, 3, v16
    v_lshlrev_b32 v17, 9, v17
    v_and_b32 v15, 1, v15
    v_lshlrev_b32 v15, 2, v15
    v_lshl_or_b32 v16, v16, 3, v15
    v_and_b32 v18, 3, v1
    s_mul_i32 s33, s26, 9
    v_add_u32 v19, s33, v18
    v_add_u32 v20, 18, v19
    v_xor_b32 v20, v20, v16
    v_lshl_add_u32 v4, v20, 3, v17
    v_add_u32 v20, 23, v19
    v_xor_b32 v20, v20, v16
    v_lshl_add_u32 v5, v20, 3, v17
    v_add_u32 v20, 36, v19
    v_xor_b32 v20, v20, v16
    v_lshl_add_u32 v6, v20, 3, v17
    v_add_u32 v20, 41, v19
    v_xor_b32 v20, v20, v16
    v_lshl_add_u32 v7, v20, 3, v17
    s_add_u32 s33, s33, 4
    v_mad_u32_u24 v20, v18, 18, s33
    v_min_u32 v20, 54, v20
    v_xor_b32 v20, v20, v16
    v_lshl_add_u32 v8, v20, 3, v17
    v_add_u32 v20, 0, v19
    v_xor_b32 v20, v20, v16
    v_lshl_add_u32 v9, v20, 3, v17
    v_add_u32 v20, 5, v19
    v_xor_b32 v20, v20, v16
    v_lshl_add_u32 v10, v20, 3, v17
    s_waitcnt lgkmcnt(0)
    s_mov_b32 s12, s82
    s_mov_b32 s13, s83
    s_mov_b32 s14, 268435456
    s_mov_b32 s15, 0x20000
    s_mov_b32 s48, s82
    s_mov_b32 s49, s83
    s_mov_b32 s50, 0
    s_mov_b32 s51, 0x20000
    s_mov_b32 s60, s80
    s_mov_b32 s61, s81
    s_mov_b32 s62, 256
    s_mov_b32 s63, 0x20000
    s_mov_b32 s52, s68
    s_mov_b32 s53, s69
    s_mov_b32 s54, 663552
    s_mov_b32 s55, 0x20000
    s_or_b32 s32, s2, s20
    s_cbranch_scc1 L_c_notag
    s_mov_b32 s32, 25296896
    s_load_dword s24, s[82:83], s32 glc
    s_waitcnt lgkmcnt(0)
    s_lshr_b32 s24, s24, 4
    s_mul_i32 s24, s24, 0x2c9277b5
    s_add_u32 s24, s24, 0xac564b05
    s_lshl_b32 s24, s24, 4
    s_or_b32 s24, s24, 8
    v_mov_b32 v22, s24
    s_mov_b64 exec, 1
    buffer_store_dword v22, off, s[60:63], 0 sc1
    buffer_store_dword v22, off, s[12:15], s32 sc1
    s_mov_b64 exec, -1
L_c_notag:
    v_and_b32 v14, 31, v1
    v_lshlrev_b32_e64 v14, v14, -2
    v_lshrrev_b32 v15, 5, v1
    v_lshlrev_b32 v15, 2, v15
    v_ashrrev_i32 v14, v15, v14
    s_mov_b32 s32, 0xff800000
    v_bfe_i32 v15, v14, 0, 1
    v_and_b32 v192, s32, v15
    v_xor_b32 v208, s32, v192
    v_bfe_i32 v15, v14, 1, 1
    v_and_b32 v193, s32, v15
    v_xor_b32 v209, s32, v193
    v_bfe_i32 v15, v14, 2, 1
    v_and_b32 v194, s32, v15
    v_xor_b32 v210, s32, v194
    v_bfe_i32 v15, v14, 3, 1
    v_and_b32 v195, s32, v15
    v_xor_b32 v211, s32, v195
    v_bfe_i32 v15, v14, 8, 1
    v_and_b32 v196, s32, v15
    v_xor_b32 v212, s32, v196
    v_bfe_i32 v15, v14, 9, 1
    v_and_b32 v197, s32, v15
    v_xor_b32 v213, s32, v197
    v_bfe_i32 v15, v14, 10, 1
    v_and_b32 v198, s32, v15
    v_xor_b32 v214, s32, v198
    v_bfe_i32 v15, v14, 11, 1
    v_and_b32 v199, s32, v15
    v_xor_b32 v215, s32, v199
    v_bfe_i32 v15, v14, 16, 1
    v_and_b32 v200, s32, v15
    v_xor_b32 v216, s32, v200
    v_bfe_i32 v15, v14, 17, 1
    v_and_b32 v201, s32, v15
    v_xor_b32 v217, s32, v201
    v_bfe_i32 v15, v14, 18, 1
    v_and_b32 v202, s32, v15
    v_xor_b32 v218, s32, v202
    v_bfe_i32 v15, v14, 19, 1
    v_and_b32 v203, s32, v15
    v_xor_b32 v219, s32, v203
    v_bfe_i32 v15, v14, 24, 1
    v_and_b32 v204, s32, v15
    v_xor_b32 v220, s32, v204
    v_bfe_i32 v15, v14, 25, 1
    v_and_b32 v205, s32, v15
    v_xor_b32 v221, s32, v205
    v_bfe_i32 v15, v14, 26, 1
    v_and_b32 v206, s32, v15
    v_xor_b32 v222, s32, v206
    v_bfe_i32 v15, v14, 27, 1
    v_and_b32 v207, s32, v15
    v_xor_b32 v223, s32, v207
    s_and_b32 s45, s20, 3
    s_cmp_lt_u32 s20, 4
    s_cselect_b32 s46, 2, 0
    s_mul_i32 s43, s45, 29184
    s_mul_i32 s32, s46, 2432
    s_add_u32 s32, s32, s43
    v_lshlrev_b32 v185, 4, v1
    v_and_b32 v186, 31, v1
    v_lshlrev_b32 v186, 2, v186
    s_lshl_b32 s33, s45, 2
    s_add_u32 s33, s33, s46
    s_lshl_b32 s34, s33, 10
    s_add_u32 s34, s34, 116736
    v_add_u32 v182, s34, v185
    s_lshl_b32 s34, s33, 7
    s_add_u32 s34, s34, 133120
    v_add_u32 v183, s34, v186
    s_lshl_b32 s34, s46, 7
    s_add_u32 s34, s34, 135168
    v_add_u32 v184, s34, v186
    v_add_u32 v176, s32, v185
    v_add_u32 v177, s32, v186
    v_lshrrev_b32 v14, 5, v1
    v_bfe_u32 v15, v1, 2, 2
    v_bfe_u32 v190, v1, 1, 1
    v_xor_b32 v191, v14, v190
    v_lshl_add_u32 v191, v191, 2, v15
    v_lshlrev_b32 v191, 4, v191
    v_lshl_add_u32 v191, v190, 9, v191
    v_and_b32 v190, 1, v1
    v_lshl_add_u32 v191, v190, 3, v191
    v_lshlrev_b32 v15, 3, v15
    v_lshl_add_u32 v15, v14, 5, v15
    v_and_b32 v190, 16, v1
    v_cmp_ne_u32 vcc, 0, v190
    v_add_u32 v191, s32, v191
    v_add_u32 v15, s32, v15
    v_add_u32 v252, 0, v191
    v_add_u32 v255, 1152, v15
    v_cndmask_b32 v178, v252, v255, vcc
    v_add_u32 v252, 128, v191
    v_add_u32 v255, 1024, v15
    v_cndmask_b32 v179, v252, v255, vcc
    v_add_u32 v252, 256, v191
    v_add_u32 v255, 1216, v15
    v_cndmask_b32 v180, v252, v255, vcc
    v_add_u32 v252, 384, v191
    v_add_u32 v255, 1088, v15
    v_cndmask_b32 v181, v252, v255, vcc
    v_subrev_u32 v187, 1, v14
    s_lshl_b32 s32, s21, 2
    s_add_u32 s32, s32, s46
    s_mul_i32 s32, s32, 72
    s_lshl_b32 s33, s22, 1
    s_add_u32 s32, s32, s33
    s_lshr_b32 s33, s45, 1
    s_add_u32 s32, s32, s33
    s_lshl_b32 s32, s32, 10
    s_and_b32 s33, s45, 1
    s_lshl_b32 s33, s33, 9
    s_add_u32 s32, s32, s33
    s_add_u32 s56, s32, 16777216
    s_add_u32 s57, s56, 73728
    v_and_b32 v15, 15, v1
    v_lshlrev_b32 v15, 4, v15
    v_lshl_add_u32 v15, v14, 8, v15
    v_bfe_u32 v190, v1, 4, 1
    v_mul_u32_u24 v190, 36864, v190
    v_add_u32 v188, v15, v190
    s_lshl_b32 s33, s46, 9
    s_lshl_b32 s34, s45, 2
    s_add_u32 s33, s33, s34
    s_add_u32 s33, s33, 149504
    v_lshl_add_u32 v189, v186, 2, s33
    s_lshl_b32 s32, s22, 4
    s_add_u32 s32, s32, s21
    s_mul_i32 s44, s32, 38912
    s_lshl_b32 s47, s21, 2
    s_add_u32 s47, s47, s46
    s_sub_u32 s47, 8, s47
    s_lshl_b32 s94, s45, 13
    s_add_u32 s93, s94, 116736
    s_and_b32 s73, s45, 1
    s_mul_i32 s73, s73, 331776
    s_add_u32 s73, s73, s41
    s_lshr_b32 s35, s40, 1
    s_add_u32 s35, s35, 2
    s_lshl_b32 s39, s35, 2
    s_and_b32 s33, s40, 1
    s_add_u32 s39, s39, s33
    s_add_u32 s94, s94, 16777216
    s_lshl_b32 s95, s45, 9
    s_add_u32 s95, s95, 25231360
    s_mul_i32 s90, s45, 7168
    s_sub_u32 s90, 32768, s90
    s_bfe_u32 s89, s41, 0x10007
    s_lshr_b32 s32, s41, 7
    s_mul_i32 s33, s32, 86
    s_lshr_b32 s33, s33, 8
    s_mul_i32 s33, s33, 3
    s_sub_u32 s98, s32, s33
    s_cmp_lt_u32 s40, 16
    s_cselect_b32 s98, s98, s89
    s_cselect_b32 s34, 3, 2
    s_lshl_b32 s66, s35, 11
    s_add_u32 s66, s66, s95
    s_add_u32 s66, s66, 32768
    s_lshl_b32 s32, s39, 1
    s_add_u32 s32, s32, s89
    s_mul_i32 s87, s32, 36864
    s_add_u32 s87, s87, s94
    s_xor_b32 s32, s32, 1
    s_mul_i32 s88, s32, 36864
    s_add_u32 s88, s88, s94
    s_bfe_u32 s64, s3, 0x50018
    s_lshl_b32 s64, s64, 11
    s_add_u32 s64, s64, s95
    s_bitcmp1_b32 s3, 29
    s_cselect_b32 s65, 0xff, 15
    s_sub_u32 s95, s93, s43
    s_lshl_b32 s32, s98, 3
    s_lshr_b32 s32, s3, s32
    s_and_b32 s32, s32, 0xff
    s_mul_i32 s85, s32, 36864
    s_add_u32 s85, s85, s94
    s_mul_i32 s77, s98, 4352
    s_add_u32 s77, s77, 19456
    s_cmp_eq_u32 s98, 2
    s_cselect_b32 s77, s95, s77
    s_add_u32 s98, s98, 1
    s_cmp_eq_u32 s98, s34
    s_cselect_b32 s98, 0, s98
    s_lshl_b32 s32, s98, 3
    s_lshr_b32 s32, s3, s32
    s_and_b32 s32, s32, 0xff
    s_mul_i32 s86, s32, 36864
    s_add_u32 s86, s86, s94
    s_mul_i32 s92, s98, 4352
    s_add_u32 s92, s92, 19456
    s_cmp_eq_u32 s98, 2
    s_cselect_b32 s92, s95, s92
    s_add_u32 s98, s98, 1
    s_cmp_eq_u32 s98, s34
    s_cselect_b32 s98, 0, s98
    s_cmp_eq_u32 s34, 3
    s_cselect_b32 s98, s98, 2
    s_lshl_b32 s32, s98, 3
    s_lshr_b32 s32, s3, s32
    s_and_b32 s32, s32, 0xff
    s_mul_i32 s84, s32, 36864
    s_add_u32 s84, s84, s94
    s_mul_i32 s76, s98, 4352
    s_add_u32 s76, s76, 19456
    s_cmp_eq_u32 s98, 2
    s_cselect_b32 s76, s95, s76
    s_lshl_b32 s32, s39, 3
    s_add_u32 s32, s32, s20
    s_mul_i32 s91, s32, 4608
    s_add_u32 s91, s91, s41
    s_lshl_b32 s71, s21, 4
    s_add_u32 s71, s71, s22
    s_lshl_b32 s71, s71, 7
    s_add_u32 s71, s71, 25231360
    s_mul_i32 s32, s21, 294912
    s_lshl_b32 s33, s22, 8
    s_add_u32 s32, s32, s33
    s_add_u32 s72, s32, 16957440
    s_mov_b32 s16, s78
    s_mov_b32 s17, s79
    s_mov_b32 s18, 2359296
    s_mov_b32 s19, 0x20000
    s_mov_b32 s50, 268435456
    v_lshrrev_b32 v15, 5, v1
    v_bfe_u32 v190, v1, 4, 1
    v_and_b32 v191, 15, v1
    v_lshl_add_u32 v191, v15, 4, v191
    v_lshlrev_b32 v191, 4, v191
    v_lshl_add_u32 v240, v190, 9, v191
    v_lshlrev_b32 v191, 6, v190
    v_xor_b32 v241, v240, v191
    s_mul_i32 s34, s27, 4864
    s_mul_i32 s35, s26, 58368
    s_add_u32 s35, s35, s34
    v_add_u32 v242, s35, v240
    v_add_u32 v243, s35, v241
    s_lshl_b32 s32, s26, 13
    s_lshl_b32 s33, s27, 11
    s_add_u32 s32, s32, s33
    s_add_u32 s33, s32, 116736
    v_add_u32 v244, s33, v240
    v_mul_u32_u24 v191, 248, v15
    v_sub_u32 v244, v244, v191
    v_mul_u32_u24 v15, 2432, v15
    v_add_u32 v245, v15, v186
    v_bfe_u32 v191, v1, 3, 1
    v_xor_b32 v191, 1, v191
    v_lshlrev_b32 v191, 7, v191
    v_lshl_add_u32 v191, v190, 6, v191
    v_and_b32 v190, 7, v1
    v_lshl_add_u32 v191, v190, 3, v191
    v_add_u32 v246, v15, v191
    v_add_u32 v247, s35, v245
    v_add_u32 v11, s35, v246
    v_lshlrev_b32 v190, 2, v1
    s_lshr_b32 s32, s32, 3
    s_add_u32 s32, s32, 133120
    v_add_u32 v12, s32, v190
    s_lshl_b32 s32, s27, 8
    s_add_u32 s32, s32, 135168
    v_add_u32 v13, s32, v190
    s_mul_i32 s28, s26, 19456
    s_add_u32 s28, s28, s34
    s_add_u32 s28, s28, s44
    s_add_u32 s29, s28, 9728
    s_lshl_b32 s59, s22, 4
    s_add_u32 s59, s59, s21
    s_lshl_b32 s59, s59, 7
    s_lshl_b32 s32, s20, 2
    s_add_u32 s59, s59, s32
    s_add_u32 s59, s59, 25165824
    s_mov_b32 s38, 0x3eae1a93
    s_mov_b32 s39, s38
    s_mov_b32 s37, 0xbfb8aa3b
    s_cmp_ge_u32 s22, 8
    s_cselect_b32 s37, 0x3fb8aa3b, s37
    v_cmp_gt_u32 vcc, 16, v1
    v_cmp_le_u32 s[30:31], 48, v1
    v_mov_b32 v190, s38
    v_mov_b32 v248, 151552
    v_cndmask_b32 v60, 1.0, v190, vcc
    v_mov_b32 v251, 0x3f80
    v_mov_b32 v253, 0x3f80
    s_barrier
    ds_read_b128 v[16:19], v2 offset:0
    ds_read_b64_tr_b16 v[32:33], v4 offset:16384
    ds_read_b64_tr_b16 v[34:35], v4 offset:18432
    ds_read_b128 v[20:23], v2 offset:2048
    ds_read_b128 v[24:27], v2 offset:4096
    ds_read_b128 v[28:31], v2 offset:6144
    ds_read_b64_tr_b16 v[36:37], v5 offset:16384
    ds_read_b64_tr_b16 v[38:39], v5 offset:18432
    ds_read_b64_tr_b16 v[40:41], v6 offset:16384
    ds_read_b64_tr_b16 v[42:43], v6 offset:18432
    ds_read_b64_tr_b16 v[44:45], v7 offset:16384
    ds_read_b64_tr_b16 v[46:47], v7 offset:18432
    ds_read_b64_tr_b16 v[48:49], v8 offset:16384
    ds_read_b64_tr_b16 v[50:51], v8 offset:18432
    ds_read_b64_tr_b16 v[52:53], v9 offset:16384
    ds_read_b64_tr_b16 v[54:55], v9 offset:18432
    ds_read_b64_tr_b16 v[56:57], v10 offset:16384
    ds_read_b64_tr_b16 v[58:59], v10 offset:18432
    s_waitcnt lgkmcnt(8)
    v_mfma_f32_16x16x32_bf16 v[64:67], v[32:35], v[16:19], 0
    v_mfma_f32_16x16x32_bf16 v[68:71], v[32:35], v[20:23], 0
    v_mfma_f32_16x16x32_bf16 v[72:75], v[32:35], v[24:27], 0
    v_mfma_f32_16x16x32_bf16 v[76:79], v[32:35], v[28:31], 0
    v_mfma_f32_16x16x32_bf16 v[80:83], v[36:39], v[16:19], 0
    v_mfma_f32_16x16x32_bf16 v[84:87], v[36:39], v[20:23], 0
    v_mfma_f32_16x16x32_bf16 v[88:91], v[36:39], v[24:27], 0
    v_mfma_f32_16x16x32_bf16 v[92:95], v[36:39], v[28:31], 0
    v_mfma_f32_16x16x32_bf16 v[96:99], v[40:43], v[16:19], 0
    v_mfma_f32_16x16x32_bf16 v[100:103], v[40:43], v[20:23], 0
    v_mfma_f32_16x16x32_bf16 v[104:107], v[40:43], v[24:27], 0
    v_mfma_f32_16x16x32_bf16 v[108:111], v[40:43], v[28:31], 0
    s_waitcnt lgkmcnt(0)
    v_mfma_f32_16x16x32_bf16 v[112:115], v[44:47], v[16:19], 0
    v_mfma_f32_16x16x32_bf16 v[116:119], v[44:47], v[20:23], 0
    v_mfma_f32_16x16x32_bf16 v[120:123], v[44:47], v[24:27], 0
    v_mfma_f32_16x16x32_bf16 v[124:127], v[44:47], v[28:31], 0
    s_barrier
    ds_read_b128 v[224:227], v3 offset:0
    ds_read_b64_tr_b16 v[32:33], v4 offset:32768
    v_mfma_f32_16x16x32_bf16 v[128:131], v[48:51], v[16:19], 0
    ds_read_b64_tr_b16 v[34:35], v4 offset:34816
    ds_read_b128 v[228:231], v3 offset:2048
    v_mfma_f32_16x16x32_bf16 v[132:135], v[48:51], v[20:23], 0
    ds_read_b128 v[232:235], v3 offset:4096
    ds_read_b128 v[236:239], v3 offset:6144
    v_mfma_f32_16x16x32_bf16 v[136:139], v[48:51], v[24:27], 0
    ds_read_b64_tr_b16 v[36:37], v5 offset:32768
    ds_read_b64_tr_b16 v[38:39], v5 offset:34816
    v_mfma_f32_16x16x32_bf16 v[140:143], v[48:51], v[28:31], 0
    ds_read_b64_tr_b16 v[40:41], v6 offset:32768
    ds_read_b64_tr_b16 v[42:43], v6 offset:34816
    v_mfma_f32_16x16x32_bf16 v[144:147], v[52:55], v[16:19], 0
    ds_read_b64_tr_b16 v[44:45], v7 offset:32768
    ds_read_b64_tr_b16 v[46:47], v7 offset:34816
    v_mfma_f32_16x16x32_bf16 v[148:151], v[52:55], v[20:23], 0
    ds_read_b64_tr_b16 v[48:49], v8 offset:32768
    ds_read_b64_tr_b16 v[50:51], v8 offset:34816
    v_mfma_f32_16x16x32_bf16 v[152:155], v[52:55], v[24:27], 0
    v_mfma_f32_16x16x32_bf16 v[156:159], v[52:55], v[28:31], 0
    ds_read_b64_tr_b16 v[52:53], v9 offset:32768
    ds_read_b64_tr_b16 v[54:55], v9 offset:34816
    v_mfma_f32_16x16x32_bf16 v[160:163], v[56:59], v[16:19], 0
    v_mfma_f32_16x16x32_bf16 v[164:167], v[56:59], v[20:23], 0
    v_mfma_f32_16x16x32_bf16 v[168:171], v[56:59], v[24:27], 0
    v_mfma_f32_16x16x32_bf16 v[172:175], v[56:59], v[28:31], 0
    ds_read_b64_tr_b16 v[56:57], v10 offset:32768
    ds_read_b64_tr_b16 v[58:59], v10 offset:34816
    s_mov_b32 s24, 0
    s_mov_b32 s58, 1
    s_mov_b32 s32, 49152
    s_mov_b32 s3, 0
    s_mov_b32 s34, 49152
    s_mov_b32 s33, 0xfffe8000
L_c_loop:
    s_waitcnt lgkmcnt(8)
    v_mfma_f32_16x16x32_bf16 v[64:67], v[32:35], v[224:227], v[64:67]
    v_add_u32 v2, s32, v2
    v_mfma_f32_16x16x32_bf16 v[68:71], v[32:35], v[228:231], v[68:71]
    v_add_u32 v3, s32, v3
    v_mfma_f32_16x16x32_bf16 v[72:75], v[32:35], v[232:235], v[72:75]
    v_add_u32 v4, s32, v4
    v_mfma_f32_16x16x32_bf16 v[76:79], v[32:35], v[236:239], v[76:79]
    v_add_u32 v5, s32, v5
    v_mfma_f32_16x16x32_bf16 v[80:83], v[36:39], v[224:227], v[80:83]
    v_add_u32 v6, s32, v6
    v_mfma_f32_16x16x32_bf16 v[84:87], v[36:39], v[228:231], v[84:87]
    v_add_u32 v7, s32, v7
    v_mfma_f32_16x16x32_bf16 v[88:91], v[36:39], v[232:235], v[88:91]
    v_add_u32 v8, s32, v8
    v_mfma_f32_16x16x32_bf16 v[92:95], v[36:39], v[236:239], v[92:95]
    v_add_u32 v9, s32, v9
    v_mfma_f32_16x16x32_bf16 v[96:99], v[40:43], v[224:227], v[96:99]
    v_add_u32 v10, s32, v10
    v_mfma_f32_16x16x32_bf16 v[100:103], v[40:43], v[228:231], v[100:103]
    v_mfma_f32_16x16x32_bf16 v[104:107], v[40:43], v[232:235], v[104:107]
    v_mfma_f32_16x16x32_bf16 v[108:111], v[40:43], v[236:239], v[108:111]
    s_waitcnt lgkmcnt(0)
    v_mfma_f32_16x16x32_bf16 v[112:115], v[44:47], v[224:227], v[112:115]
    v_mfma_f32_16x16x32_bf16 v[116:119], v[44:47], v[228:231], v[116:119]
    v_mfma_f32_16x16x32_bf16 v[120:123], v[44:47], v[232:235], v[120:123]
    v_mfma_f32_16x16x32_bf16 v[124:127], v[44:47], v[236:239], v[124:127]
    s_barrier
    ds_read_b128 v[16:19], v2 offset:0
    ds_read_b64_tr_b16 v[32:33], v4 offset:16384
    v_mfma_f32_16x16x32_bf16 v[128:131], v[48:51], v[224:227], v[128:131]
    ds_read_b64_tr_b16 v[34:35], v4 offset:18432
    ds_read_b128 v[20:23], v2 offset:2048
    v_mfma_f32_16x16x32_bf16 v[132:135], v[48:51], v[228:231], v[132:135]
    ds_read_b128 v[24:27], v2 offset:4096
    ds_read_b128 v[28:31], v2 offset:6144
    v_mfma_f32_16x16x32_bf16 v[136:139], v[48:51], v[232:235], v[136:139]
    ds_read_b64_tr_b16 v[36:37], v5 offset:16384
    ds_read_b64_tr_b16 v[38:39], v5 offset:18432
    v_mfma_f32_16x16x32_bf16 v[140:143], v[48:51], v[236:239], v[140:143]
    ds_read_b64_tr_b16 v[40:41], v6 offset:16384
    ds_read_b64_tr_b16 v[42:43], v6 offset:18432
    v_mfma_f32_16x16x32_bf16 v[144:147], v[52:55], v[224:227], v[144:147]
    ds_read_b64_tr_b16 v[44:45], v7 offset:16384
    ds_read_b64_tr_b16 v[46:47], v7 offset:18432
    v_mfma_f32_16x16x32_bf16 v[148:151], v[52:55], v[228:231], v[148:151]
    ds_read_b64_tr_b16 v[48:49], v8 offset:16384
    ds_read_b64_tr_b16 v[50:51], v8 offset:18432
    v_mfma_f32_16x16x32_bf16 v[152:155], v[52:55], v[232:235], v[152:155]
    v_mfma_f32_16x16x32_bf16 v[156:159], v[52:55], v[236:239], v[156:159]
    ds_read_b64_tr_b16 v[52:53], v9 offset:16384
    ds_read_b64_tr_b16 v[54:55], v9 offset:18432
    v_mfma_f32_16x16x32_bf16 v[160:163], v[56:59], v[224:227], v[160:163]
    v_mfma_f32_16x16x32_bf16 v[164:167], v[56:59], v[228:231], v[164:167]
    v_mfma_f32_16x16x32_bf16 v[168:171], v[56:59], v[232:235], v[168:171]
    v_mfma_f32_16x16x32_bf16 v[172:175], v[56:59], v[236:239], v[172:175]
    ds_read_b64_tr_b16 v[56:57], v10 offset:16384
    ds_read_b64_tr_b16 v[58:59], v10 offset:18432
    s_waitcnt lgkmcnt(8)
    v_mfma_f32_16x16x32_bf16 v[64:67], v[32:35], v[16:19], v[64:67]
    s_add_u32 s58, s58, 1
    v_mfma_f32_16x16x32_bf16 v[68:71], v[32:35], v[20:23], v[68:71]
    s_cmp_eq_u32 s58, 3
    v_mfma_f32_16x16x32_bf16 v[72:75], v[32:35], v[24:27], v[72:75]
    s_cselect_b32 s58, 0, s58
    v_mfma_f32_16x16x32_bf16 v[76:79], v[32:35], v[28:31], v[76:79]
    s_cselect_b32 s32, s33, s34
    v_mfma_f32_16x16x32_bf16 v[80:83], v[36:39], v[16:19], v[80:83]
    s_add_u32 s24, s24, 1
    v_mfma_f32_16x16x32_bf16 v[84:87], v[36:39], v[20:23], v[84:87]
    s_cmp_lt_u32 s24, 8
    v_mfma_f32_16x16x32_bf16 v[88:91], v[36:39], v[24:27], v[88:91]
    v_mfma_f32_16x16x32_bf16 v[92:95], v[36:39], v[28:31], v[92:95]
    v_mfma_f32_16x16x32_bf16 v[96:99], v[40:43], v[16:19], v[96:99]
    v_mfma_f32_16x16x32_bf16 v[100:103], v[40:43], v[20:23], v[100:103]
    v_mfma_f32_16x16x32_bf16 v[104:107], v[40:43], v[24:27], v[104:107]
    v_mfma_f32_16x16x32_bf16 v[108:111], v[40:43], v[28:31], v[108:111]
    s_waitcnt lgkmcnt(0)
    v_mfma_f32_16x16x32_bf16 v[112:115], v[44:47], v[16:19], v[112:115]
    v_mfma_f32_16x16x32_bf16 v[116:119], v[44:47], v[20:23], v[116:119]
    v_mfma_f32_16x16x32_bf16 v[120:123], v[44:47], v[24:27], v[120:123]
    v_mfma_f32_16x16x32_bf16 v[124:127], v[44:47], v[28:31], v[124:127]
    s_barrier
    ds_read_b64 v[14:15], v248
    ds_read_b128 v[224:227], v3 offset:0
    ds_read_b64_tr_b16 v[32:33], v4 offset:32768
    v_mfma_f32_16x16x32_bf16 v[128:131], v[48:51], v[16:19], v[128:131]
    ds_read_b64_tr_b16 v[34:35], v4 offset:34816
    ds_read_b128 v[228:231], v3 offset:2048
    v_mfma_f32_16x16x32_bf16 v[132:135], v[48:51], v[20:23], v[132:135]
    ds_read_b128 v[232:235], v3 offset:4096
    ds_read_b128 v[236:239], v3 offset:6144
    v_mfma_f32_16x16x32_bf16 v[136:139], v[48:51], v[24:27], v[136:139]
    ds_read_b64_tr_b16 v[36:37], v5 offset:32768
    ds_read_b64_tr_b16 v[38:39], v5 offset:34816
    v_mfma_f32_16x16x32_bf16 v[140:143], v[48:51], v[28:31], v[140:143]
    ds_read_b64_tr_b16 v[40:41], v6 offset:32768
    ds_read_b64_tr_b16 v[42:43], v6 offset:34816
    v_mfma_f32_16x16x32_bf16 v[144:147], v[52:55], v[16:19], v[144:147]
    ds_read_b64_tr_b16 v[44:45], v7 offset:32768
    ds_read_b64_tr_b16 v[46:47], v7 offset:34816
    v_mfma_f32_16x16x32_bf16 v[148:151], v[52:55], v[20:23], v[148:151]
    ds_read_b64_tr_b16 v[48:49], v8 offset:32768
    ds_read_b64_tr_b16 v[50:51], v8 offset:34816
    v_mfma_f32_16x16x32_bf16 v[152:155], v[52:55], v[24:27], v[152:155]
    v_mfma_f32_16x16x32_bf16 v[156:159], v[52:55], v[28:31], v[156:159]
    ds_read_b64_tr_b16 v[52:53], v9 offset:32768
    ds_read_b64_tr_b16 v[54:55], v9 offset:34816
    v_mfma_f32_16x16x32_bf16 v[160:163], v[56:59], v[16:19], v[160:163]
    v_mfma_f32_16x16x32_bf16 v[164:167], v[56:59], v[20:23], v[164:167]
    v_mfma_f32_16x16x32_bf16 v[168:171], v[56:59], v[24:27], v[168:171]
    v_mfma_f32_16x16x32_bf16 v[172:175], v[56:59], v[28:31], v[172:175]
    ds_read_b64_tr_b16 v[56:57], v10 offset:32768
    ds_read_b64_tr_b16 v[58:59], v10 offset:34816
    s_cbranch_scc1 L_c_loop
    s_waitcnt lgkmcnt(15)
    v_readfirstlane_b32 s25, v15
    v_readfirstlane_b32 s23, v14
    s_nop 1
    s_cmp_ge_u32 s25, s27
    s_cbranch_scc1 L_epi_cross
    s_waitcnt lgkmcnt(8)
    v_mfma_f32_16x16x32_bf16 v[64:67], v[32:35], v[224:227], v[64:67]
    v_mfma_f32_16x16x32_bf16 v[68:71], v[32:35], v[228:231], v[68:71]
    v_mfma_f32_16x16x32_bf16 v[72:75], v[32:35], v[232:235], v[72:75]
    v_mfma_f32_16x16x32_bf16 v[76:79], v[32:35], v[236:239], v[76:79]
    v_mfma_f32_16x16x32_bf16 v[80:83], v[36:39], v[224:227], v[80:83]
    v_mfma_f32_16x16x32_bf16 v[84:87], v[36:39], v[228:231], v[84:87]
    v_mfma_f32_16x16x32_bf16 v[88:91], v[36:39], v[232:235], v[88:91]
    v_mfma_f32_16x16x32_bf16 v[92:95], v[36:39], v[236:239], v[92:95]
    s_waitcnt lgkmcnt(0)
    s_barrier
    v_mfma_f32_16x16x32_bf16 v[96:99], v[40:43], v[224:227], v[96:99]
    v_cvt_pk_bf16_f32 v64, v64, v65
    v_cvt_pk_bf16_f32 v65, v66, v67
    v_mfma_f32_16x16x32_bf16 v[100:103], v[40:43], v[228:231], v[100:103]
    v_cvt_pk_bf16_f32 v66, v68, v69
    v_cvt_pk_bf16_f32 v67, v70, v71
    v_mfma_f32_16x16x32_bf16 v[104:107], v[40:43], v[232:235], v[104:107]
    v_cvt_pk_bf16_f32 v72, v72, v73
    v_cvt_pk_bf16_f32 v73, v74, v75
    v_mfma_f32_16x16x32_bf16 v[108:111], v[40:43], v[236:239], v[108:111]
    v_cvt_pk_bf16_f32 v74, v76, v77
    v_cvt_pk_bf16_f32 v75, v78, v79
    v_mfma_f32_16x16x32_bf16 v[112:115], v[44:47], v[224:227], v[112:115]
    v_permlane32_swap_b32 v64, v66
    v_permlane32_swap_b32 v65, v67
    v_mfma_f32_16x16x32_bf16 v[116:119], v[44:47], v[228:231], v[116:119]
    ds_write_b128 v242, v[64:67] offset:20864
    v_permlane32_swap_b32 v72, v74
    v_mfma_f32_16x16x32_bf16 v[120:123], v[44:47], v[232:235], v[120:123]
    v_permlane32_swap_b32 v73, v75
    ds_write_b128 v242, v[72:75] offset:23296
    v_mfma_f32_16x16x32_bf16 v[124:127], v[44:47], v[236:239], v[124:127]
    buffer_store_dwordx4 v[64:67], v240, s[48:51], s28 offen offset:1408
    buffer_store_dwordx4 v[72:75], v240, s[48:51], s28 offen offset:3840
    v_mfma_f32_16x16x32_bf16 v[128:131], v[48:51], v[224:227], v[128:131]
    v_cvt_pk_bf16_f32 v80, v80, v81
    v_cvt_pk_bf16_f32 v81, v82, v83
    v_mfma_f32_16x16x32_bf16 v[132:135], v[48:51], v[228:231], v[132:135]
    v_cvt_pk_bf16_f32 v82, v84, v85
    v_cvt_pk_bf16_f32 v83, v86, v87
    v_mfma_f32_16x16x32_bf16 v[136:139], v[48:51], v[232:235], v[136:139]
    v_cvt_pk_bf16_f32 v88, v88, v89
    v_cvt_pk_bf16_f32 v89, v90, v91
    v_mfma_f32_16x16x32_bf16 v[140:143], v[48:51], v[236:239], v[140:143]
    v_cvt_pk_bf16_f32 v90, v92, v93
    v_cvt_pk_bf16_f32 v91, v94, v95
    v_mfma_f32_16x16x32_bf16 v[144:147], v[52:55], v[224:227], v[144:147]
    v_permlane32_swap_b32 v80, v82
    v_permlane32_swap_b32 v81, v83
    v_mfma_f32_16x16x32_bf16 v[148:151], v[52:55], v[228:231], v[148:151]
    ds_write_b128 v242, v[80:83] offset:50048
    v_permlane32_swap_b32 v88, v90
    v_mfma_f32_16x16x32_bf16 v[152:155], v[52:55], v[232:235], v[152:155]
    v_permlane32_swap_b32 v89, v91
    ds_write_b128 v242, v[88:91] offset:52480
    v_mfma_f32_16x16x32_bf16 v[156:159], v[52:55], v[236:239], v[156:159]
    buffer_store_dwordx4 v[80:83], v240, s[48:51], s29 offen offset:1408
    v_cvt_pk_bf16_f32 v96, v96, v97
    v_mfma_f32_16x16x32_bf16 v[160:163], v[56:59], v[224:227], v[160:163]
    v_cvt_pk_bf16_f32 v97, v98, v99
    v_cvt_pk_bf16_f32 v98, v100, v101
    v_mfma_f32_16x16x32_bf16 v[164:167], v[56:59], v[228:231], v[164:167]
    v_cvt_pk_bf16_f32 v99, v102, v103
    v_cvt_pk_bf16_f32 v104, v104, v105
    v_mfma_f32_16x16x32_bf16 v[168:171], v[56:59], v[232:235], v[168:171]
    v_cvt_pk_bf16_f32 v105, v106, v107
    v_cvt_pk_bf16_f32 v106, v108, v109
    v_mfma_f32_16x16x32_bf16 v[172:175], v[56:59], v[236:239], v[172:175]
    v_cvt_pk_bf16_f32 v107, v110, v111
    v_permlane32_swap_b32 v96, v98
    v_permlane32_swap_b32 v97, v99
    ds_write_b128 v243, v[96:99] offset:19456
    v_permlane32_swap_b32 v104, v106
    v_permlane32_swap_b32 v105, v107
    ds_write_b128 v243, v[104:107] offset:21888
    buffer_store_dwordx4 v[88:91], v240, s[48:51], s29 offen offset:3840
    v_cvt_pk_bf16_f32 v112, v112, v113
    v_cvt_pk_bf16_f32 v113, v114, v115
    v_cvt_pk_bf16_f32 v114, v116, v117
    v_cvt_pk_bf16_f32 v115, v118, v119
    v_cvt_pk_bf16_f32 v120, v120, v121
    v_cvt_pk_bf16_f32 v121, v122, v123
    v_cvt_pk_bf16_f32 v122, v124, v125
    v_cvt_pk_bf16_f32 v123, v126, v127
    v_permlane32_swap_b32 v112, v114
    v_permlane32_swap_b32 v113, v115
    ds_write_b128 v243, v[112:115] offset:48640
    v_permlane32_swap_b32 v120, v122
    v_permlane32_swap_b32 v121, v123
    ds_write_b128 v243, v[120:123] offset:51072
    buffer_store_dwordx4 v[96:99], v241, s[48:51], s28 offen offset:0
    v_pk_mul_f32 v[128:129], v[128:129], v[60:61] op_sel_hi:[1,0]
    v_pk_mul_f32 v[130:131], v[130:131], v[60:61] op_sel_hi:[1,0]
    v_pk_mul_f32 v[132:133], v[132:133], v[60:61] op_sel_hi:[1,0]
    v_pk_mul_f32 v[134:135], v[134:135], v[60:61] op_sel_hi:[1,0]
    v_pk_mul_f32 v[136:137], v[136:137], v[60:61] op_sel_hi:[1,0]
    v_pk_mul_f32 v[138:139], v[138:139], v[60:61] op_sel_hi:[1,0]
    v_pk_mul_f32 v[140:141], v[140:141], v[60:61] op_sel_hi:[1,0]
    v_pk_mul_f32 v[142:143], v[142:143], v[60:61] op_sel_hi:[1,0]
    v_cvt_pk_bf16_f32 v62, v128, v129
    v_cvt_pk_bf16_f32 v129, v130, v131
    v_cndmask_b32_e64 v128, v62, v128, s[30:31]
    v_cvt_pk_bf16_f32 v62, v132, v133
    v_cvt_pk_bf16_f32 v191, v134, v135
    v_cndmask_b32_e64 v190, v62, v132, s[30:31]
    v_cvt_pk_bf16_f32 v62, v136, v137
    v_cvt_pk_bf16_f32 v252, v138, v139
    v_cndmask_b32_e64 v250, v62, v136, s[30:31]
    v_cvt_pk_bf16_f32 v62, v140, v141
    v_cvt_pk_bf16_f32 v141, v142, v143
    v_cndmask_b32_e64 v140, v62, v140, s[30:31]
    buffer_store_dwordx4 v[104:107], v241, s[48:51], s28 offen offset:2432
    s_nop 0
    v_permlane32_swap_b32 v129, v252
    v_permlane32_swap_b32 v191, v141
    v_permlane32_swap_b32 v128, v250
    v_permlane32_swap_b32 v190, v140
    v_permlane16_swap_b32 v129, v191
    v_permlane16_swap_b32 v252, v141
    v_permlane16_swap_b32 v128, v190
    v_permlane16_swap_b32 v250, v140
    v_mul_f32 v140, s37, v140
    ds_write_b32 v247, v190 offset:20736
    v_exp_f32 v140, v140
    ds_write_b32 v247, v191 offset:49920
    ds_write_b64 v11, v[250:251] offset:20480
    v_add_f32 v140, 1.0, v140
    ds_write_b64 v11, v[252:253] offset:49664
    ds_write_b32 v12, v128
    ds_write_b32 v12, v129 offset:512
    ds_write_b32 v13, v140
    buffer_store_dwordx4 v[112:115], v241, s[48:51], s29 offen offset:0
    v_pk_mul_f32 v[144:145], v[144:145], s[38:39]
    v_pk_mul_f32 v[146:147], v[146:147], s[38:39]
    v_pk_mul_f32 v[148:149], v[148:149], s[38:39]
    v_pk_mul_f32 v[150:151], v[150:151], s[38:39]
    v_pk_mul_f32 v[152:153], v[152:153], s[38:39]
    v_pk_mul_f32 v[154:155], v[154:155], s[38:39]
    v_pk_mul_f32 v[156:157], v[156:157], s[38:39]
    v_pk_mul_f32 v[158:159], v[158:159], s[38:39]
    v_cvt_pk_bf16_f32 v144, v144, v145
    v_cvt_pk_bf16_f32 v145, v146, v147
    v_cvt_pk_bf16_f32 v146, v148, v149
    v_cvt_pk_bf16_f32 v147, v150, v151
    v_cvt_pk_bf16_f32 v152, v152, v153
    v_cvt_pk_bf16_f32 v153, v154, v155
    v_cvt_pk_bf16_f32 v154, v156, v157
    v_cvt_pk_bf16_f32 v155, v158, v159
    ds_write_b64 v244, v[144:145] offset:0
    ds_write_b64 v244, v[146:147] offset:256
    ds_write_b64 v244, v[152:153] offset:1024
    ds_write_b64 v244, v[154:155] offset:1280
    buffer_store_dwordx4 v[120:123], v241, s[48:51], s29 offen offset:2432
    v_pk_mul_f32 v[160:161], v[160:161], s[38:39]
    v_pk_mul_f32 v[162:163], v[162:163], s[38:39]
    v_pk_mul_f32 v[164:165], v[164:165], s[38:39]
    v_pk_mul_f32 v[166:167], v[166:167], s[38:39]
    v_pk_mul_f32 v[168:169], v[168:169], s[38:39]
    v_pk_mul_f32 v[170:171], v[170:171], s[38:39]
    v_pk_mul_f32 v[172:173], v[172:173], s[38:39]
    v_pk_mul_f32 v[174:175], v[174:175], s[38:39]
    v_cvt_pk_bf16_f32 v160, v160, v161
    v_cvt_pk_bf16_f32 v161, v162, v163
    v_cvt_pk_bf16_f32 v162, v164, v165
    v_cvt_pk_bf16_f32 v163, v166, v167
    v_cvt_pk_bf16_f32 v168, v168, v169
    v_cvt_pk_bf16_f32 v169, v170, v171
    v_cvt_pk_bf16_f32 v170, v172, v173
    v_cvt_pk_bf16_f32 v171, v174, v175
    ds_write_b64 v244, v[160:161] offset:4096
    ds_write_b64 v244, v[162:163] offset:4352
    ds_write_b64 v244, v[168:169] offset:5120
    ds_write_b64 v244, v[170:171] offset:5376
    s_waitcnt lgkmcnt(0)
    s_barrier
    buffer_store_dword v190, v245, s[48:51], s28 offen offset:1280
    buffer_store_dword v191, v245, s[48:51], s29 offen offset:1280
    buffer_store_dwordx2 v[250:251], v246, s[48:51], s28 offen offset:1024
    buffer_store_dwordx2 v[252:253], v246, s[48:51], s29 offen offset:1024
    s_branch L_attn
    .p2align 6
L_epi_cross_pad:
    s_branch L_epi_cross_ret
L_epi_cross:
    s_waitcnt lgkmcnt(8)
    v_mfma_f32_16x16x32_bf16 v[64:67], v[32:35], v[224:227], v[64:67]
    v_mfma_f32_16x16x32_bf16 v[68:71], v[32:35], v[228:231], v[68:71]
    v_mfma_f32_16x16x32_bf16 v[72:75], v[32:35], v[232:235], v[72:75]
    v_mfma_f32_16x16x32_bf16 v[76:79], v[32:35], v[236:239], v[76:79]
    v_mfma_f32_16x16x32_bf16 v[80:83], v[36:39], v[224:227], v[80:83]
    v_mfma_f32_16x16x32_bf16 v[84:87], v[36:39], v[228:231], v[84:87]
    v_mfma_f32_16x16x32_bf16 v[88:91], v[36:39], v[232:235], v[88:91]
    v_mfma_f32_16x16x32_bf16 v[92:95], v[36:39], v[236:239], v[92:95]
    s_waitcnt lgkmcnt(0)
    s_barrier
    v_mfma_f32_16x16x32_bf16 v[96:99], v[40:43], v[224:227], v[96:99]
    v_cvt_pk_bf16_f32 v64, v64, v65
    v_cvt_pk_bf16_f32 v65, v66, v67
    v_mfma_f32_16x16x32_bf16 v[100:103], v[40:43], v[228:231], v[100:103]
    v_cvt_pk_bf16_f32 v66, v68, v69
    v_cvt_pk_bf16_f32 v67, v70, v71
    v_mfma_f32_16x16x32_bf16 v[104:107], v[40:43], v[232:235], v[104:107]
    v_cvt_pk_bf16_f32 v72, v72, v73
    v_cvt_pk_bf16_f32 v73, v74, v75
    v_mfma_f32_16x16x32_bf16 v[108:111], v[40:43], v[236:239], v[108:111]
    v_cvt_pk_bf16_f32 v74, v76, v77
    v_cvt_pk_bf16_f32 v75, v78, v79
    v_mfma_f32_16x16x32_bf16 v[112:115], v[44:47], v[224:227], v[112:115]
    v_permlane32_swap_b32 v64, v66
    v_permlane32_swap_b32 v65, v67
    v_mfma_f32_16x16x32_bf16 v[116:119], v[44:47], v[228:231], v[116:119]
    ds_write_b128 v242, v[64:67] offset:20864
    v_permlane32_swap_b32 v72, v74
    v_mfma_f32_16x16x32_bf16 v[120:123], v[44:47], v[232:235], v[120:123]
    v_permlane32_swap_b32 v73, v75
    ds_write_b128 v242, v[72:75] offset:23296
    v_mfma_f32_16x16x32_bf16 v[124:127], v[44:47], v[236:239], v[124:127]
    buffer_store_dwordx4 v[64:67], v240, s[48:51], s28 offen offset:1408 sc1
    buffer_store_dwordx4 v[72:75], v240, s[48:51], s28 offen offset:3840 sc1
    v_mfma_f32_16x16x32_bf16 v[128:131], v[48:51], v[224:227], v[128:131]
    v_cvt_pk_bf16_f32 v80, v80, v81
    v_cvt_pk_bf16_f32 v81, v82, v83
    v_mfma_f32_16x16x32_bf16 v[132:135], v[48:51], v[228:231], v[132:135]
    v_cvt_pk_bf16_f32 v82, v84, v85
    v_cvt_pk_bf16_f32 v83, v86, v87
    v_mfma_f32_16x16x32_bf16 v[136:139], v[48:51], v[232:235], v[136:139]
    v_cvt_pk_bf16_f32 v88, v88, v89
    v_cvt_pk_bf16_f32 v89, v90, v91
    v_mfma_f32_16x16x32_bf16 v[140:143], v[48:51], v[236:239], v[140:143]
    v_cvt_pk_bf16_f32 v90, v92, v93
    v_cvt_pk_bf16_f32 v91, v94, v95
    v_mfma_f32_16x16x32_bf16 v[144:147], v[52:55], v[224:227], v[144:147]
    v_permlane32_swap_b32 v80, v82
    v_permlane32_swap_b32 v81, v83
    v_mfma_f32_16x16x32_bf16 v[148:151], v[52:55], v[228:231], v[148:151]
    ds_write_b128 v242, v[80:83] offset:50048
    v_permlane32_swap_b32 v88, v90
    v_mfma_f32_16x16x32_bf16 v[152:155], v[52:55], v[232:235], v[152:155]
    v_permlane32_swap_b32 v89, v91
    ds_write_b128 v242, v[88:91] offset:52480
    v_mfma_f32_16x16x32_bf16 v[156:159], v[52:55], v[236:239], v[156:159]
    buffer_store_dwordx4 v[80:83], v240, s[48:51], s29 offen offset:1408 sc1
    v_cvt_pk_bf16_f32 v96, v96, v97
    v_mfma_f32_16x16x32_bf16 v[160:163], v[56:59], v[224:227], v[160:163]
    v_cvt_pk_bf16_f32 v97, v98, v99
    v_cvt_pk_bf16_f32 v98, v100, v101
    v_mfma_f32_16x16x32_bf16 v[164:167], v[56:59], v[228:231], v[164:167]
    v_cvt_pk_bf16_f32 v99, v102, v103
    v_cvt_pk_bf16_f32 v104, v104, v105
    v_mfma_f32_16x16x32_bf16 v[168:171], v[56:59], v[232:235], v[168:171]
    v_cvt_pk_bf16_f32 v105, v106, v107
    v_cvt_pk_bf16_f32 v106, v108, v109
    v_mfma_f32_16x16x32_bf16 v[172:175], v[56:59], v[236:239], v[172:175]
    v_cvt_pk_bf16_f32 v107, v110, v111
    v_permlane32_swap_b32 v96, v98
    v_permlane32_swap_b32 v97, v99
    ds_write_b128 v243, v[96:99] offset:19456
    v_permlane32_swap_b32 v104, v106
    v_permlane32_swap_b32 v105, v107
    ds_write_b128 v243, v[104:107] offset:21888
    buffer_store_dwordx4 v[88:91], v240, s[48:51], s29 offen offset:3840 sc1
    v_cvt_pk_bf16_f32 v112, v112, v113
    v_cvt_pk_bf16_f32 v113, v114, v115
    v_cvt_pk_bf16_f32 v114, v116, v117
    v_cvt_pk_bf16_f32 v115, v118, v119
    v_cvt_pk_bf16_f32 v120, v120, v121
    v_cvt_pk_bf16_f32 v121, v122, v123
    v_cvt_pk_bf16_f32 v122, v124, v125
    v_cvt_pk_bf16_f32 v123, v126, v127
    v_permlane32_swap_b32 v112, v114
    v_permlane32_swap_b32 v113, v115
    ds_write_b128 v243, v[112:115] offset:48640
    v_permlane32_swap_b32 v120, v122
    v_permlane32_swap_b32 v121, v123
    ds_write_b128 v243, v[120:123] offset:51072
    buffer_store_dwordx4 v[96:99], v241, s[48:51], s28 offen offset:0 sc1
    v_pk_mul_f32 v[128:129], v[128:129], v[60:61] op_sel_hi:[1,0]
    v_pk_mul_f32 v[130:131], v[130:131], v[60:61] op_sel_hi:[1,0]
    v_pk_mul_f32 v[132:133], v[132:133], v[60:61] op_sel_hi:[1,0]
    v_pk_mul_f32 v[134:135], v[134:135], v[60:61] op_sel_hi:[1,0]
    v_pk_mul_f32 v[136:137], v[136:137], v[60:61] op_sel_hi:[1,0]
    v_pk_mul_f32 v[138:139], v[138:139], v[60:61] op_sel_hi:[1,0]
    v_pk_mul_f32 v[140:141], v[140:141], v[60:61] op_sel_hi:[1,0]
    v_pk_mul_f32 v[142:143], v[142:143], v[60:61] op_sel_hi:[1,0]
    v_cvt_pk_bf16_f32 v62, v128, v129
    v_cvt_pk_bf16_f32 v129, v130, v131
    v_cndmask_b32_e64 v128, v62, v128, s[30:31]
    v_cvt_pk_bf16_f32 v62, v132, v133
    v_cvt_pk_bf16_f32 v191, v134, v135
    v_cndmask_b32_e64 v190, v62, v132, s[30:31]
    v_cvt_pk_bf16_f32 v62, v136, v137
    v_cvt_pk_bf16_f32 v252, v138, v139
    v_cndmask_b32_e64 v250, v62, v136, s[30:31]
    v_cvt_pk_bf16_f32 v62, v140, v141
    v_cvt_pk_bf16_f32 v141, v142, v143
    v_cndmask_b32_e64 v140, v62, v140, s[30:31]
    buffer_store_dwordx4 v[104:107], v241, s[48:51], s28 offen offset:2432 sc1
    s_nop 0
    v_permlane32_swap_b32 v129, v252
    v_permlane32_swap_b32 v191, v141
    v_permlane32_swap_b32 v128, v250
    v_permlane32_swap_b32 v190, v140
    v_permlane16_swap_b32 v129, v191
    v_permlane16_swap_b32 v252, v141
    v_permlane16_swap_b32 v128, v190
    v_permlane16_swap_b32 v250, v140
    v_mul_f32 v140, s37, v140
    ds_write_b32 v247, v190 offset:20736
    v_exp_f32 v140, v140
    ds_write_b32 v247, v191 offset:49920
    ds_write_b64 v11, v[250:251] offset:20480
    v_add_f32 v140, 1.0, v140
    ds_write_b64 v11, v[252:253] offset:49664
    ds_write_b32 v12, v128
    ds_write_b32 v12, v129 offset:512
    ds_write_b32 v13, v140
    buffer_store_dwordx4 v[112:115], v241, s[48:51], s29 offen offset:0 sc1
    v_pk_mul_f32 v[144:145], v[144:145], s[38:39]
    v_pk_mul_f32 v[146:147], v[146:147], s[38:39]
    v_pk_mul_f32 v[148:149], v[148:149], s[38:39]
    v_pk_mul_f32 v[150:151], v[150:151], s[38:39]
    v_pk_mul_f32 v[152:153], v[152:153], s[38:39]
    v_pk_mul_f32 v[154:155], v[154:155], s[38:39]
    v_pk_mul_f32 v[156:157], v[156:157], s[38:39]
    v_pk_mul_f32 v[158:159], v[158:159], s[38:39]
    v_cvt_pk_bf16_f32 v144, v144, v145
    v_cvt_pk_bf16_f32 v145, v146, v147
    v_cvt_pk_bf16_f32 v146, v148, v149
    v_cvt_pk_bf16_f32 v147, v150, v151
    v_cvt_pk_bf16_f32 v152, v152, v153
    v_cvt_pk_bf16_f32 v153, v154, v155
    v_cvt_pk_bf16_f32 v154, v156, v157
    v_cvt_pk_bf16_f32 v155, v158, v159
    ds_write_b64 v244, v[144:145] offset:0
    ds_write_b64 v244, v[146:147] offset:256
    ds_write_b64 v244, v[152:153] offset:1024
    ds_write_b64 v244, v[154:155] offset:1280
    buffer_store_dwordx4 v[120:123], v241, s[48:51], s29 offen offset:2432 sc1
    v_pk_mul_f32 v[160:161], v[160:161], s[38:39]
    v_pk_mul_f32 v[162:163], v[162:163], s[38:39]
    v_pk_mul_f32 v[164:165], v[164:165], s[38:39]
    v_pk_mul_f32 v[166:167], v[166:167], s[38:39]
    v_pk_mul_f32 v[168:169], v[168:169], s[38:39]
    v_pk_mul_f32 v[170:171], v[170:171], s[38:39]
    v_pk_mul_f32 v[172:173], v[172:173], s[38:39]
    v_pk_mul_f32 v[174:175], v[174:175], s[38:39]
    v_cvt_pk_bf16_f32 v160, v160, v161
    v_cvt_pk_bf16_f32 v161, v162, v163
    v_cvt_pk_bf16_f32 v162, v164, v165
    v_cvt_pk_bf16_f32 v163, v166, v167
    v_cvt_pk_bf16_f32 v168, v168, v169
    v_cvt_pk_bf16_f32 v169, v170, v171
    v_cvt_pk_bf16_f32 v170, v172, v173
    v_cvt_pk_bf16_f32 v171, v174, v175
    ds_write_b64 v244, v[160:161] offset:4096
    ds_write_b64 v244, v[162:163] offset:4352
    ds_write_b64 v244, v[168:169] offset:5120
    ds_write_b64 v244, v[170:171] offset:5376
    s_waitcnt lgkmcnt(0)
    s_barrier
    buffer_store_dword v190, v245, s[48:51], s28 offen offset:1280 sc1
    buffer_store_dword v191, v245, s[48:51], s29 offen offset:1280 sc1
    buffer_store_dwordx2 v[250:251], v246, s[48:51], s28 offen offset:1024 sc1
    buffer_store_dwordx2 v[252:253], v246, s[48:51], s29 offen offset:1024 sc1
    s_branch L_attn
    .p2align 6
L_attn_pad:
    s_branch L_attn_ret
L_attn:
    ds_read_b32 v44, v183 offset:128
    ds_read_b32 v36, v183
    ds_read_b128 v[40:43], v182 offset:1024
    ds_read_b32 v54, v177 offset:23168
    ds_read_b128 v[56:59], v176 offset:23296
    ds_read_b64_tr_b16 v[128:129], v178 offset:21888
    ds_read_b64_tr_b16 v[130:131], v179 offset:21888
    ds_read_b64_tr_b16 v[132:133], v180 offset:21888
    ds_read_b64_tr_b16 v[134:135], v181 offset:21888
    ds_read_b128 v[32:35], v182
    s_cmp_lg_u32 s3, 0
    s_cbranch_scc1 L_nokvflag1
    s_cmp_lg_u32 s27, 1
    s_cbranch_scc1 L_nokvflag1
    s_mov_b64 exec, 1
    s_cmp_lg_u32 s25, 0
    s_waitcnt vmcnt(0)
    s_cbranch_scc1 L_kvflag_x1
    buffer_store_dword v14, off, s[12:15], s59
    s_branch L_kvflag_j1
L_kvflag_x1:
    buffer_store_dword v14, off, s[12:15], s59 sc1
L_kvflag_j1:
    s_mov_b64 exec, -1
L_nokvflag1:
    v_mov_b32 v37, 0
    v_mov_b32 v38, 0
    v_mov_b32 v39, 0
    v_mov_b32 v45, 0
    v_mov_b32 v46, 0
    v_mov_b32 v47, 0
    v_mov_b32 v49, 0
    v_mov_b32 v55, 0
    s_waitcnt lgkmcnt(8)
    v_and_b32 v44, v44, v187
    v_and_b32 v36, v36, v187
    s_waitcnt lgkmcnt(5)
    v_mfma_f32_32x32x16_bf16 v[96:111], v[54:57], v[44:47], v[192:207]
    v_mfma_f32_32x32x16_bf16 v[96:111], v[56:59], v[40:43], v[96:111]
    ds_read_b32 v48, v177 offset:20736
    ds_read_b128 v[50:53], v176 offset:20864
    ds_read_b64_tr_b16 v[144:145], v178 offset:19456
    ds_read_b64_tr_b16 v[146:147], v179 offset:19456
    ds_read_b64_tr_b16 v[148:149], v180 offset:19456
    ds_read_b64_tr_b16 v[150:151], v181 offset:19456
    ds_read_b32 v60, v184
    ds_read_b32 v61, v184 offset:128
    s_nop 1
    s_waitcnt lgkmcnt(6)
    v_mfma_f32_32x32x16_bf16 v[112:127], v[48:51], v[36:39], v[192:207]
    v_exp_f32 v96, v96
    v_exp_f32 v97, v97
    v_exp_f32 v98, v98
    v_exp_f32 v99, v99
    v_cvt_pk_bf16_f32 v24, v96, v97
    v_cvt_pk_bf16_f32 v25, v98, v99
    v_mfma_f32_32x32x16_bf16 v[112:127], v[50:53], v[32:35], v[112:127]
    v_exp_f32 v100, v100
    v_exp_f32 v101, v101
    v_exp_f32 v102, v102
    v_exp_f32 v103, v103
    v_cvt_pk_bf16_f32 v26, v100, v101
    v_cvt_pk_bf16_f32 v27, v102, v103
    v_exp_f32 v104, v104
    v_exp_f32 v105, v105
    v_exp_f32 v106, v106
    v_exp_f32 v107, v107
    v_cvt_pk_bf16_f32 v28, v104, v105
    v_cvt_pk_bf16_f32 v29, v106, v107
    v_mfma_f32_32x32x16_bf16 v[80:95], v[128:131], v[24:27], 0
    v_exp_f32 v108, v108
    v_exp_f32 v109, v109
    v_exp_f32 v110, v110
    v_exp_f32 v111, v111
    v_cvt_pk_bf16_f32 v30, v108, v109
    v_cvt_pk_bf16_f32 v31, v110, v111
    s_cmp_lg_u32 s3, 0
    s_cbranch_scc1 L_nokvflag0
    s_cmp_lg_u32 s27, 0
    s_cbranch_scc1 L_nokvflag0
    s_mov_b64 exec, 1
    s_cmp_lg_u32 s25, 0
    s_waitcnt vmcnt(0)
    s_cbranch_scc1 L_kvflag_x0
    buffer_store_dword v14, off, s[12:15], s59
    s_branch L_kvflag_j0
L_kvflag_x0:
    buffer_store_dword v14, off, s[12:15], s59 sc1
L_kvflag_j0:
    s_mov_b64 exec, -1
L_nokvflag0:
    v_mfma_f32_32x32x16_bf16 v[96:111], v[48:51], v[44:47], 0
    v_exp_f32 v112, v112
    v_exp_f32 v113, v113
    v_exp_f32 v114, v114
    v_exp_f32 v115, v115
    v_cvt_pk_bf16_f32 v24, v112, v113
    v_cvt_pk_bf16_f32 v25, v114, v115
    v_mfma_f32_32x32x16_bf16 v[96:111], v[50:53], v[40:43], v[96:111]
    v_exp_f32 v116, v116
    v_exp_f32 v117, v117
    v_exp_f32 v118, v118
    v_exp_f32 v119, v119
    v_cvt_pk_bf16_f32 v26, v116, v117
    v_cvt_pk_bf16_f32 v27, v118, v119
    v_mfma_f32_32x32x16_bf16 v[80:95], v[132:135], v[28:31], v[80:95]
    v_exp_f32 v120, v120
    v_exp_f32 v121, v121
    v_exp_f32 v122, v122
    v_exp_f32 v123, v123
    v_cvt_pk_bf16_f32 v28, v120, v121
    v_cvt_pk_bf16_f32 v29, v122, v123
    s_cmp_eq_u32 s3, 1
    s_cbranch_scc1 L_hook7
L_hs7:
    ds_read_b32 v54, v177 offset:18304
    ds_read_b128 v[56:59], v176 offset:18432
    ds_read_b64_tr_b16 v[136:137], v178 offset:17024
    ds_read_b64_tr_b16 v[138:139], v179 offset:17024
    ds_read_b64_tr_b16 v[140:141], v180 offset:17024
    ds_read_b64_tr_b16 v[142:143], v181 offset:17024
    s_waitcnt lgkmcnt(8)
    v_mfma_f32_32x32x16_bf16 v[64:79], v[144:147], v[24:27], 0
    v_exp_f32 v124, v124
    v_exp_f32 v125, v125
    v_exp_f32 v126, v126
    v_exp_f32 v127, v127
    v_cvt_pk_bf16_f32 v30, v124, v125
    v_cvt_pk_bf16_f32 v31, v126, v127
    s_waitcnt lgkmcnt(4)
    v_mfma_f32_32x32x16_bf16 v[112:127], v[54:57], v[36:39], 0
    v_exp_f32 v96, v96
    v_exp_f32 v97, v97
    v_exp_f32 v98, v98
    v_exp_f32 v99, v99
    v_cvt_pk_bf16_f32 v24, v96, v97
    v_cvt_pk_bf16_f32 v25, v98, v99
    v_mfma_f32_32x32x16_bf16 v[112:127], v[56:59], v[32:35], v[112:127]
    ds_read_b32 v48, v177 offset:15872
    ds_read_b128 v[50:53], v176 offset:16000
    ds_read_b64_tr_b16 v[128:129], v178 offset:14592
    ds_read_b64_tr_b16 v[130:131], v179 offset:14592
    ds_read_b64_tr_b16 v[132:133], v180 offset:14592
    ds_read_b64_tr_b16 v[134:135], v181 offset:14592
    v_exp_f32 v100, v100
    v_exp_f32 v101, v101
    v_exp_f32 v102, v102
    v_exp_f32 v103, v103
    v_cvt_pk_bf16_f32 v26, v100, v101
    v_cvt_pk_bf16_f32 v27, v102, v103
    v_mfma_f32_32x32x16_bf16 v[64:79], v[148:151], v[28:31], v[64:79]
    v_exp_f32 v104, v104
    v_exp_f32 v105, v105
    v_exp_f32 v106, v106
    v_exp_f32 v107, v107
    v_cvt_pk_bf16_f32 v28, v104, v105
    v_cvt_pk_bf16_f32 v29, v106, v107
    v_mfma_f32_32x32x16_bf16 v[80:95], v[144:147], v[24:27], v[80:95]
    s_cmp_eq_u32 s47, 8
    v_exp_f32 v108, v108
    v_exp_f32 v109, v109
    v_exp_f32 v110, v110
    v_exp_f32 v111, v111
    v_cvt_pk_bf16_f32 v30, v108, v109
    v_cvt_pk_bf16_f32 v31, v110, v111
    s_cbranch_scc1 L_short2
    s_cmp_lg_u32 s3, 1
    s_cbranch_scc1 L_nosig
    s_waitcnt vmcnt(1)
    s_mov_b64 exec, 1
    ds_write_b32 v168, v161
    s_mov_b64 exec, -1
L_nosig:
    v_mfma_f32_32x32x16_bf16 v[96:111], v[54:57], v[44:47], 0
    v_exp_f32 v112, v112
    v_exp_f32 v113, v113
    v_exp_f32 v114, v114
    v_exp_f32 v115, v115
    v_cvt_pk_bf16_f32 v24, v112, v113
    v_cvt_pk_bf16_f32 v25, v114, v115
    v_mfma_f32_32x32x16_bf16 v[96:111], v[56:59], v[40:43], v[96:111]
    v_exp_f32 v116, v116
    v_exp_f32 v117, v117
    v_exp_f32 v118, v118
    v_exp_f32 v119, v119
    v_cvt_pk_bf16_f32 v26, v116, v117
    v_cvt_pk_bf16_f32 v27, v118, v119
    v_mfma_f32_32x32x16_bf16 v[80:95], v[148:151], v[28:31], v[80:95]
    v_exp_f32 v120, v120
    v_exp_f32 v121, v121
    v_exp_f32 v122, v122
    v_exp_f32 v123, v123
    v_cvt_pk_bf16_f32 v28, v120, v121
    v_cvt_pk_bf16_f32 v29, v122, v123
    s_waitcnt lgkmcnt(6)
    v_mfma_f32_32x32x16_bf16 v[64:79], v[136:139], v[24:27], v[64:79]
    v_exp_f32 v124, v124
    v_exp_f32 v125, v125
    v_exp_f32 v126, v126
    v_exp_f32 v127, v127
    v_cvt_pk_bf16_f32 v30, v124, v125
    v_cvt_pk_bf16_f32 v31, v126, v127
    s_cmp_lg_u32 s3, 1
    s_cbranch_scc1 L_nolup
    s_setprio 1
L_nolup:
    s_waitcnt lgkmcnt(0)
    v_mfma_f32_32x32x16_bf16 v[112:127], v[48:51], v[36:39], 0
    v_exp_f32 v96, v96
    v_exp_f32 v97, v97
    v_exp_f32 v98, v98
    v_exp_f32 v99, v99
    v_cvt_pk_bf16_f32 v24, v96, v97
    v_cvt_pk_bf16_f32 v25, v98, v99
    v_mfma_f32_32x32x16_bf16 v[112:127], v[50:53], v[32:35], v[112:127]
    v_exp_f32 v100, v100
    v_exp_f32 v101, v101
    v_exp_f32 v102, v102
    v_exp_f32 v103, v103
    v_cvt_pk_bf16_f32 v26, v100, v101
    v_cvt_pk_bf16_f32 v27, v102, v103
    v_mfma_f32_32x32x16_bf16 v[64:79], v[140:143], v[28:31], v[64:79]
    v_exp_f32 v104, v104
    v_exp_f32 v105, v105
    v_exp_f32 v106, v106
    v_exp_f32 v107, v107
    v_cvt_pk_bf16_f32 v28, v104, v105
    v_cvt_pk_bf16_f32 v29, v106, v107
    v_mfma_f32_32x32x16_bf16 v[80:95], v[136:139], v[24:27], v[80:95]
    v_exp_f32 v108, v108
    v_exp_f32 v109, v109
    v_exp_f32 v110, v110
    v_exp_f32 v111, v111
    v_cvt_pk_bf16_f32 v30, v108, v109
    v_cvt_pk_bf16_f32 v31, v110, v111
    v_mfma_f32_32x32x16_bf16 v[96:111], v[48:51], v[44:47], 0
    v_exp_f32 v112, v112
    v_exp_f32 v113, v113
    v_exp_f32 v114, v114
    v_exp_f32 v115, v115
    v_cvt_pk_bf16_f32 v24, v112, v113
    v_cvt_pk_bf16_f32 v25, v114, v115
    v_mfma_f32_32x32x16_bf16 v[96:111], v[50:53], v[40:43], v[96:111]
    v_exp_f32 v116, v116
    v_exp_f32 v117, v117
    v_exp_f32 v118, v118
    v_exp_f32 v119, v119
    v_cvt_pk_bf16_f32 v26, v116, v117
    v_cvt_pk_bf16_f32 v27, v118, v119
    v_mfma_f32_32x32x16_bf16 v[80:95], v[140:143], v[28:31], v[80:95]
    v_exp_f32 v120, v120
    v_exp_f32 v121, v121
    v_exp_f32 v122, v122
    v_exp_f32 v123, v123
    v_cvt_pk_bf16_f32 v28, v120, v121
    v_cvt_pk_bf16_f32 v29, v122, v123
    s_cmp_lg_u32 s3, 0
    s_cbranch_scc1 L_hs5
    v_lshrrev_b32 v3, 4, v1
    v_and_b32 v2, 15, v1
    v_mul_u32_u24 v163, 36864, v3
    v_lshl_add_u32 v163, v2, 4, v163
    v_mov_b32 v160, 151568
    v_mov_b32 v161, 1
    v_add_u32 v162, 150528, v185
    s_setprio 2
    s_waitcnt lgkmcnt(0)
    s_barrier
L_hs5:
    ds_read_b32 v54, v177 offset:13440
    ds_read_b128 v[56:59], v176 offset:13568
    ds_read_b64_tr_b16 v[144:145], v178 offset:12160
    ds_read_b64_tr_b16 v[146:147], v179 offset:12160
    ds_read_b64_tr_b16 v[148:149], v180 offset:12160
    ds_read_b64_tr_b16 v[150:151], v181 offset:12160
    v_mfma_f32_32x32x16_bf16 v[64:79], v[128:131], v[24:27], v[64:79]
    v_exp_f32 v124, v124
    v_exp_f32 v125, v125
    v_exp_f32 v126, v126
    v_exp_f32 v127, v127
    v_cvt_pk_bf16_f32 v30, v124, v125
    v_cvt_pk_bf16_f32 v31, v126, v127
    s_waitcnt lgkmcnt(4)
    v_mfma_f32_32x32x16_bf16 v[112:127], v[54:57], v[36:39], 0
    v_exp_f32 v96, v96
    v_exp_f32 v97, v97
    v_exp_f32 v98, v98
    v_exp_f32 v99, v99
    v_cvt_pk_bf16_f32 v24, v96, v97
    v_cvt_pk_bf16_f32 v25, v98, v99
    v_mfma_f32_32x32x16_bf16 v[112:127], v[56:59], v[32:35], v[112:127]
    ds_read_b32 v48, v177 offset:11008
    ds_read_b128 v[50:53], v176 offset:11136
    ds_read_b64_tr_b16 v[136:137], v178 offset:9728
    ds_read_b64_tr_b16 v[138:139], v179 offset:9728
    ds_read_b64_tr_b16 v[140:141], v180 offset:9728
    ds_read_b64_tr_b16 v[142:143], v181 offset:9728
    v_exp_f32 v100, v100
    v_exp_f32 v101, v101
    v_exp_f32 v102, v102
    v_exp_f32 v103, v103
    v_cvt_pk_bf16_f32 v26, v100, v101
    v_cvt_pk_bf16_f32 v27, v102, v103
    v_mfma_f32_32x32x16_bf16 v[64:79], v[132:135], v[28:31], v[64:79]
    v_exp_f32 v104, v104
    v_exp_f32 v105, v105
    v_exp_f32 v106, v106
    v_exp_f32 v107, v107
    v_cvt_pk_bf16_f32 v28, v104, v105
    v_cvt_pk_bf16_f32 v29, v106, v107
    v_mfma_f32_32x32x16_bf16 v[80:95], v[128:131], v[24:27], v[80:95]
    s_cmp_eq_u32 s47, 6
    v_exp_f32 v108, v108
    v_exp_f32 v109, v109
    v_exp_f32 v110, v110
    v_exp_f32 v111, v111
    v_cvt_pk_bf16_f32 v30, v108, v109
    v_cvt_pk_bf16_f32 v31, v110, v111
    s_cbranch_scc1 L_short0
    v_mfma_f32_32x32x16_bf16 v[96:111], v[54:57], v[44:47], 0
    v_exp_f32 v112, v112
    v_exp_f32 v113, v113
    v_exp_f32 v114, v114
    v_exp_f32 v115, v115
    v_cvt_pk_bf16_f32 v24, v112, v113
    v_cvt_pk_bf16_f32 v25, v114, v115
    v_mfma_f32_32x32x16_bf16 v[96:111], v[56:59], v[40:43], v[96:111]
    v_exp_f32 v116, v116
    v_exp_f32 v117, v117
    v_exp_f32 v118, v118
    v_exp_f32 v119, v119
    v_cvt_pk_bf16_f32 v26, v116, v117
    v_cvt_pk_bf16_f32 v27, v118, v119
    v_mfma_f32_32x32x16_bf16 v[80:95], v[132:135], v[28:31], v[80:95]
    v_exp_f32 v120, v120
    v_exp_f32 v121, v121
    v_exp_f32 v122, v122
    v_exp_f32 v123, v123
    v_cvt_pk_bf16_f32 v28, v120, v121
    v_cvt_pk_bf16_f32 v29, v122, v123
    s_waitcnt lgkmcnt(6)
    v_mfma_f32_32x32x16_bf16 v[64:79], v[144:147], v[24:27], v[64:79]
    v_exp_f32 v124, v124
    v_exp_f32 v125, v125
    v_exp_f32 v126, v126
    v_exp_f32 v127, v127
    v_cvt_pk_bf16_f32 v30, v124, v125
    v_cvt_pk_bf16_f32 v31, v126, v127
    s_waitcnt lgkmcnt(0)
    v_mfma_f32_32x32x16_bf16 v[112:127], v[48:51], v[36:39], 0
    v_exp_f32 v96, v96
    v_exp_f32 v97, v97
    v_exp_f32 v98, v98
    v_exp_f32 v99, v99
    v_cvt_pk_bf16_f32 v24, v96, v97
    v_cvt_pk_bf16_f32 v25, v98, v99
    v_mfma_f32_32x32x16_bf16 v[112:127], v[50:53], v[32:35], v[112:127]
    v_exp_f32 v100, v100
    v_exp_f32 v101, v101
    v_exp_f32 v102, v102
    v_exp_f32 v103, v103
    v_cvt_pk_bf16_f32 v26, v100, v101
    v_cvt_pk_bf16_f32 v27, v102, v103
    v_mfma_f32_32x32x16_bf16 v[64:79], v[148:151], v[28:31], v[64:79]
    v_exp_f32 v104, v104
    v_exp_f32 v105, v105
    v_exp_f32 v106, v106
    v_exp_f32 v107, v107
    v_cvt_pk_bf16_f32 v28, v104, v105
    v_cvt_pk_bf16_f32 v29, v106, v107
    v_mfma_f32_32x32x16_bf16 v[80:95], v[144:147], v[24:27], v[80:95]
    v_exp_f32 v108, v108
    v_exp_f32 v109, v109
    v_exp_f32 v110, v110
    v_exp_f32 v111, v111
    v_cvt_pk_bf16_f32 v30, v108, v109
    v_cvt_pk_bf16_f32 v31, v110, v111
    v_mfma_f32_32x32x16_bf16 v[96:111], v[48:51], v[44:47], 0
    v_exp_f32 v112, v112
    v_exp_f32 v113, v113
    v_exp_f32 v114, v114
    v_exp_f32 v115, v115
    v_cvt_pk_bf16_f32 v24, v112, v113
    v_cvt_pk_bf16_f32 v25, v114, v115
    v_mfma_f32_32x32x16_bf16 v[96:111], v[50:53], v[40:43], v[96:111]
    v_exp_f32 v116, v116
    v_exp_f32 v117, v117
    v_exp_f32 v118, v118
    v_exp_f32 v119, v119
    v_cvt_pk_bf16_f32 v26, v116, v117
    v_cvt_pk_bf16_f32 v27, v118, v119
    v_mfma_f32_32x32x16_bf16 v[80:95], v[148:151], v[28:31], v[80:95]
    v_exp_f32 v120, v120
    v_exp_f32 v121, v121
    v_exp_f32 v122, v122
    v_exp_f32 v123, v123
    v_cvt_pk_bf16_f32 v28, v120, v121
    v_cvt_pk_bf16_f32 v29, v122, v123
    s_cmp_lg_u32 s3, 0
    s_cbranch_scc1 L_h1b3
    s_barrier
L_h1b3:
    ds_read_b32 v54, v177 offset:8576
    ds_read_b128 v[56:59], v176 offset:8704
    ds_read_b64_tr_b16 v[128:129], v178 offset:7296
    ds_read_b64_tr_b16 v[130:131], v179 offset:7296
    ds_read_b64_tr_b16 v[132:133], v180 offset:7296
    ds_read_b64_tr_b16 v[134:135], v181 offset:7296
    v_mfma_f32_32x32x16_bf16 v[64:79], v[136:139], v[24:27], v[64:79]
    v_exp_f32 v124, v124
    v_exp_f32 v125, v125
    v_exp_f32 v126, v126
    v_exp_f32 v127, v127
    v_cvt_pk_bf16_f32 v30, v124, v125
    v_cvt_pk_bf16_f32 v31, v126, v127
    s_waitcnt lgkmcnt(4)
    v_mfma_f32_32x32x16_bf16 v[112:127], v[54:57], v[36:39], 0
    v_exp_f32 v96, v96
    v_exp_f32 v97, v97
    v_exp_f32 v98, v98
    v_exp_f32 v99, v99
    v_cvt_pk_bf16_f32 v24, v96, v97
    v_cvt_pk_bf16_f32 v25, v98, v99
    v_mfma_f32_32x32x16_bf16 v[112:127], v[56:59], v[32:35], v[112:127]
    ds_read_b32 v48, v177 offset:6144
    ds_read_b128 v[50:53], v176 offset:6272
    ds_read_b64_tr_b16 v[144:145], v178 offset:4864
    ds_read_b64_tr_b16 v[146:147], v179 offset:4864
    ds_read_b64_tr_b16 v[148:149], v180 offset:4864
    ds_read_b64_tr_b16 v[150:151], v181 offset:4864
    v_exp_f32 v100, v100
    v_exp_f32 v101, v101
    v_exp_f32 v102, v102
    v_exp_f32 v103, v103
    v_cvt_pk_bf16_f32 v26, v100, v101
    v_cvt_pk_bf16_f32 v27, v102, v103
    v_mfma_f32_32x32x16_bf16 v[64:79], v[140:143], v[28:31], v[64:79]
    v_exp_f32 v104, v104
    v_exp_f32 v105, v105
    v_exp_f32 v106, v106
    v_exp_f32 v107, v107
    v_cvt_pk_bf16_f32 v28, v104, v105
    v_cvt_pk_bf16_f32 v29, v106, v107
    v_mfma_f32_32x32x16_bf16 v[80:95], v[136:139], v[24:27], v[80:95]
    s_cmp_eq_u32 s47, 4
    v_exp_f32 v108, v108
    v_exp_f32 v109, v109
    v_exp_f32 v110, v110
    v_exp_f32 v111, v111
    v_cvt_pk_bf16_f32 v30, v108, v109
    v_cvt_pk_bf16_f32 v31, v110, v111
    s_cbranch_scc1 L_short1
    v_mfma_f32_32x32x16_bf16 v[96:111], v[54:57], v[44:47], 0
    v_exp_f32 v112, v112
    v_exp_f32 v113, v113
    v_exp_f32 v114, v114
    v_exp_f32 v115, v115
    v_cvt_pk_bf16_f32 v24, v112, v113
    v_cvt_pk_bf16_f32 v25, v114, v115
    v_mfma_f32_32x32x16_bf16 v[96:111], v[56:59], v[40:43], v[96:111]
    v_exp_f32 v116, v116
    v_exp_f32 v117, v117
    v_exp_f32 v118, v118
    v_exp_f32 v119, v119
    v_cvt_pk_bf16_f32 v26, v116, v117
    v_cvt_pk_bf16_f32 v27, v118, v119
    v_mfma_f32_32x32x16_bf16 v[80:95], v[140:143], v[28:31], v[80:95]
    v_exp_f32 v120, v120
    v_exp_f32 v121, v121
    v_exp_f32 v122, v122
    v_exp_f32 v123, v123
    v_cvt_pk_bf16_f32 v28, v120, v121
    v_cvt_pk_bf16_f32 v29, v122, v123
    s_waitcnt lgkmcnt(6)
    v_mfma_f32_32x32x16_bf16 v[64:79], v[128:131], v[24:27], v[64:79]
    v_exp_f32 v124, v124
    v_exp_f32 v125, v125
    v_exp_f32 v126, v126
    v_exp_f32 v127, v127
    v_cvt_pk_bf16_f32 v30, v124, v125
    v_cvt_pk_bf16_f32 v31, v126, v127
    s_waitcnt lgkmcnt(0)
    v_mfma_f32_32x32x16_bf16 v[112:127], v[48:51], v[36:39], 0
    v_exp_f32 v96, v96
    v_exp_f32 v97, v97
    v_exp_f32 v98, v98
    v_exp_f32 v99, v99
    v_cvt_pk_bf16_f32 v24, v96, v97
    v_cvt_pk_bf16_f32 v25, v98, v99
    v_mfma_f32_32x32x16_bf16 v[112:127], v[50:53], v[32:35], v[112:127]
    ds_read_b32 v54, v177 offset:3712
    ds_read_b128 v[56:59], v176 offset:3840
    ds_read_b64_tr_b16 v[136:137], v178 offset:2432
    ds_read_b64_tr_b16 v[138:139], v179 offset:2432
    ds_read_b64_tr_b16 v[140:141], v180 offset:2432
    ds_read_b64_tr_b16 v[142:143], v181 offset:2432
    v_exp_f32 v100, v100
    v_exp_f32 v101, v101
    v_exp_f32 v102, v102
    v_exp_f32 v103, v103
    v_cvt_pk_bf16_f32 v26, v100, v101
    v_cvt_pk_bf16_f32 v27, v102, v103
    v_mfma_f32_32x32x16_bf16 v[64:79], v[132:135], v[28:31], v[64:79]
    v_exp_f32 v104, v104
    v_exp_f32 v105, v105
    v_exp_f32 v106, v106
    v_exp_f32 v107, v107
    v_cvt_pk_bf16_f32 v28, v104, v105
    v_cvt_pk_bf16_f32 v29, v106, v107
    v_mfma_f32_32x32x16_bf16 v[80:95], v[128:131], v[24:27], v[80:95]
    v_exp_f32 v108, v108
    v_exp_f32 v109, v109
    v_exp_f32 v110, v110
    v_exp_f32 v111, v111
    v_cvt_pk_bf16_f32 v30, v108, v109
    v_cvt_pk_bf16_f32 v31, v110, v111
    v_mfma_f32_32x32x16_bf16 v[96:111], v[48:51], v[44:47], 0
    v_exp_f32 v112, v112
    v_exp_f32 v113, v113
    v_exp_f32 v114, v114
    v_exp_f32 v115, v115
    v_cvt_pk_bf16_f32 v24, v112, v113
    v_cvt_pk_bf16_f32 v25, v114, v115
    v_mfma_f32_32x32x16_bf16 v[96:111], v[50:53], v[40:43], v[96:111]
    v_exp_f32 v116, v116
    v_exp_f32 v117, v117
    v_exp_f32 v118, v118
    v_exp_f32 v119, v119
    v_cvt_pk_bf16_f32 v26, v116, v117
    v_cvt_pk_bf16_f32 v27, v118, v119
    v_mfma_f32_32x32x16_bf16 v[80:95], v[132:135], v[28:31], v[80:95]
    v_exp_f32 v120, v120
    v_exp_f32 v121, v121
    v_exp_f32 v122, v122
    v_exp_f32 v123, v123
    v_cvt_pk_bf16_f32 v28, v120, v121
    v_cvt_pk_bf16_f32 v29, v122, v123
    v_mfma_f32_32x32x16_bf16 v[64:79], v[144:147], v[24:27], v[64:79]
    v_exp_f32 v124, v124
    v_exp_f32 v125, v125
    v_exp_f32 v126, v126
    v_exp_f32 v127, v127
    v_cvt_pk_bf16_f32 v30, v124, v125
    v_cvt_pk_bf16_f32 v31, v126, v127
    s_waitcnt lgkmcnt(0)
    v_mfma_f32_32x32x16_bf16 v[112:127], v[54:57], v[36:39], 0
    v_exp_f32 v96, v96
    v_exp_f32 v97, v97
    v_exp_f32 v98, v98
    v_exp_f32 v99, v99
    v_cvt_pk_bf16_f32 v24, v96, v97
    v_cvt_pk_bf16_f32 v25, v98, v99
    v_mfma_f32_32x32x16_bf16 v[112:127], v[56:59], v[32:35], v[112:127]
    ds_read_b32 v48, v177 offset:1280
    ds_read_b128 v[50:53], v176 offset:1408
    ds_read_b64_tr_b16 v[128:129], v178 offset:0
    ds_read_b64_tr_b16 v[130:131], v179 offset:0
    ds_read_b64_tr_b16 v[132:133], v180 offset:0
    ds_read_b64_tr_b16 v[134:135], v181 offset:0
    v_exp_f32 v100, v100
    v_exp_f32 v101, v101
    v_exp_f32 v102, v102
    v_exp_f32 v103, v103
    v_cvt_pk_bf16_f32 v26, v100, v101
    v_cvt_pk_bf16_f32 v27, v102, v103
    v_mfma_f32_32x32x16_bf16 v[64:79], v[148:151], v[28:31], v[64:79]
    v_exp_f32 v104, v104
    v_exp_f32 v105, v105
    v_exp_f32 v106, v106
    v_exp_f32 v107, v107
    v_cvt_pk_bf16_f32 v28, v104, v105
    v_cvt_pk_bf16_f32 v29, v106, v107
    v_mfma_f32_32x32x16_bf16 v[80:95], v[144:147], v[24:27], v[80:95]
    s_cmp_eq_u32 s47, 2
    v_exp_f32 v108, v108
    v_exp_f32 v109, v109
    v_exp_f32 v110, v110
    v_exp_f32 v111, v111
    v_cvt_pk_bf16_f32 v30, v108, v109
    v_cvt_pk_bf16_f32 v31, v110, v111
    s_cbranch_scc1 L_short2
    v_mfma_f32_32x32x16_bf16 v[96:111], v[54:57], v[44:47], v[208:223]
    v_exp_f32 v112, v112
    v_exp_f32 v113, v113
    v_exp_f32 v114, v114
    v_exp_f32 v115, v115
    v_cvt_pk_bf16_f32 v24, v112, v113
    v_cvt_pk_bf16_f32 v25, v114, v115
    v_mfma_f32_32x32x16_bf16 v[96:111], v[56:59], v[40:43], v[96:111]
    v_exp_f32 v116, v116
    v_exp_f32 v117, v117
    v_exp_f32 v118, v118
    v_exp_f32 v119, v119
    v_cvt_pk_bf16_f32 v26, v116, v117
    v_cvt_pk_bf16_f32 v27, v118, v119
    v_mfma_f32_32x32x16_bf16 v[80:95], v[148:151], v[28:31], v[80:95]
    v_exp_f32 v120, v120
    v_exp_f32 v121, v121
    v_exp_f32 v122, v122
    v_exp_f32 v123, v123
    v_cvt_pk_bf16_f32 v28, v120, v121
    v_cvt_pk_bf16_f32 v29, v122, v123
    v_mfma_f32_32x32x16_bf16 v[64:79], v[136:139], v[24:27], v[64:79]
    v_exp_f32 v124, v124
    v_exp_f32 v125, v125
    v_exp_f32 v126, v126
    v_exp_f32 v127, v127
    v_cvt_pk_bf16_f32 v30, v124, v125
    v_cvt_pk_bf16_f32 v31, v126, v127
    s_waitcnt lgkmcnt(0)
    v_mfma_f32_32x32x16_bf16 v[112:127], v[48:51], v[36:39], v[208:223]
    v_exp_f32 v96, v96
    v_exp_f32 v97, v97
    v_exp_f32 v98, v98
    v_exp_f32 v99, v99
    v_cvt_pk_bf16_f32 v24, v96, v97
    v_cvt_pk_bf16_f32 v25, v98, v99
    v_mfma_f32_32x32x16_bf16 v[112:127], v[50:53], v[32:35], v[112:127]
    v_exp_f32 v100, v100
    v_exp_f32 v101, v101
    v_exp_f32 v102, v102
    v_exp_f32 v103, v103
    v_cvt_pk_bf16_f32 v26, v100, v101
    v_cvt_pk_bf16_f32 v27, v102, v103
    v_mfma_f32_32x32x16_bf16 v[64:79], v[140:143], v[28:31], v[64:79]
    v_exp_f32 v104, v104
    v_exp_f32 v105, v105
    v_exp_f32 v106, v106
    v_exp_f32 v107, v107
    v_cvt_pk_bf16_f32 v28, v104, v105
    v_cvt_pk_bf16_f32 v29, v106, v107
    v_mfma_f32_32x32x16_bf16 v[80:95], v[136:139], v[24:27], v[80:95]
    v_exp_f32 v108, v108
    v_exp_f32 v109, v109
    v_exp_f32 v110, v110
    v_exp_f32 v111, v111
    v_cvt_pk_bf16_f32 v30, v108, v109
    v_cvt_pk_bf16_f32 v31, v110, v111
    v_exp_f32 v112, v112
    v_exp_f32 v113, v113
    v_exp_f32 v114, v114
    v_exp_f32 v115, v115
    v_cvt_pk_bf16_f32 v24, v112, v113
    v_cvt_pk_bf16_f32 v25, v114, v115
    v_exp_f32 v116, v116
    v_exp_f32 v117, v117
    v_exp_f32 v118, v118
    v_exp_f32 v119, v119
    v_cvt_pk_bf16_f32 v26, v116, v117
    v_cvt_pk_bf16_f32 v27, v118, v119
    v_mfma_f32_32x32x16_bf16 v[80:95], v[140:143], v[28:31], v[80:95]
    v_exp_f32 v120, v120
    v_exp_f32 v121, v121
    v_exp_f32 v122, v122
    v_exp_f32 v123, v123
    v_cvt_pk_bf16_f32 v28, v120, v121
    v_cvt_pk_bf16_f32 v29, v122, v123
    v_mfma_f32_32x32x16_bf16 v[64:79], v[128:131], v[24:27], v[64:79]
    v_exp_f32 v124, v124
    v_exp_f32 v125, v125
    v_exp_f32 v126, v126
    v_exp_f32 v127, v127
    v_cvt_pk_bf16_f32 v30, v124, v125
    v_cvt_pk_bf16_f32 v31, v126, v127
    s_nop 1
    v_mfma_f32_32x32x16_bf16 v[64:79], v[132:135], v[28:31], v[64:79]
L_attn_end:
    s_mov_b32 s24, 0
L_finish:
    v_mul_f32 v104, v61, v90
    v_rcp_f32 v104, v104
    s_nop 0
    v_pk_mul_f32 v[80:81], v[80:81], v[104:105] op_sel_hi:[1,0]
    v_pk_mul_f32 v[82:83], v[82:83], v[104:105] op_sel_hi:[1,0]
    v_pk_mul_f32 v[84:85], v[84:85], v[104:105] op_sel_hi:[1,0]
    v_pk_mul_f32 v[86:87], v[86:87], v[104:105] op_sel_hi:[1,0]
    v_pk_mul_f32 v[88:89], v[88:89], v[104:105] op_sel_hi:[1,0]
    v_cvt_pk_bf16_f32 v96, v80, v81
    v_cvt_pk_bf16_f32 v97, v82, v83
    v_cvt_pk_bf16_f32 v98, v84, v85
    v_cvt_pk_bf16_f32 v99, v86, v87
    v_cvt_pk_bf16_f32 v100, v88, v89
    buffer_store_dwordx4 v[96:99], v188, s[12:15], s57 offen sc1
    ds_write_b32 v189, v100 offset:512
    v_mul_f32 v120, v60, v74
    v_rcp_f32 v120, v120
    s_nop 0
    v_pk_mul_f32 v[64:65], v[64:65], v[120:121] op_sel_hi:[1,0]
    v_pk_mul_f32 v[66:67], v[66:67], v[120:121] op_sel_hi:[1,0]
    v_pk_mul_f32 v[68:69], v[68:69], v[120:121] op_sel_hi:[1,0]
    v_pk_mul_f32 v[70:71], v[70:71], v[120:121] op_sel_hi:[1,0]
    v_pk_mul_f32 v[72:73], v[72:73], v[120:121] op_sel_hi:[1,0]
    v_cvt_pk_bf16_f32 v112, v64, v65
    v_cvt_pk_bf16_f32 v113, v66, v67
    v_cvt_pk_bf16_f32 v114, v68, v69
    v_cvt_pk_bf16_f32 v115, v70, v71
    v_cvt_pk_bf16_f32 v116, v72, v73
    buffer_store_dwordx4 v[112:115], v188, s[12:15], s56 offen sc1
    ds_write_b32 v189, v116 offset:0
    v_dot2_f32_bf16 v90, v96, v37, v90
    v_dot2_f32_bf16 v74, v112, v37, v74
    v_dot2_f32_bf16 v90, v97, v37, v90
    v_dot2_f32_bf16 v74, v113, v37, v74
    v_dot2_f32_bf16 v90, v98, v37, v90
    v_dot2_f32_bf16 v74, v114, v37, v74
    v_dot2_f32_bf16 v90, v99, v37, v90
    v_dot2_f32_bf16 v74, v115, v37, v74
    v_dot2_f32_bf16 v90, v100, v37, v90
    v_dot2_f32_bf16 v74, v116, v37, v74
    s_mov_b32 s32, 0x21800000
    s_mov_b32 s33, 0x5d800000
    s_nop 0
    v_cmp_nle_f32 vcc, s32, v90
    v_cmp_nge_f32 s[34:35], s33, v90
    v_cmp_nle_f32 s[36:37], s32, v74
    v_cmp_nge_f32 s[38:39], s33, v74
    s_or_b64 vcc, vcc, s[34:35]
    s_or_b64 s[36:37], s[36:37], s[38:39]
    s_or_b64 vcc, vcc, s[36:37]
    s_cbranch_vccnz L_exact
L_finish_done:
    s_mov_b64 exec, 1
    ds_add_rtn_u32 v3, v160, v161 offset:0
    s_waitcnt lgkmcnt(0)
    v_readfirstlane_b32 s32, v3
    s_mov_b64 exec, -1
    s_cmp_lg_u32 s32, 3
    s_cbranch_scc1 L_noext
    ds_read_b128 v[48:51], v162
    s_waitcnt lgkmcnt(0)
    buffer_store_dwordx4 v[48:51], v163, s[12:15], s72 offen sc1
L_noext:
    s_cmp_ge_u32 s20, 4
    s_cbranch_scc1 L_op_L
    s_mov_b32 s50, 21495808
    s_cmp_eq_u32 s42, 1
    s_cselect_b32 s54, 663552, 0
    s_cmp_ge_u32 s45, 2
    s_cselect_b32 s52, s74, s68
    s_cselect_b32 s53, s75, s69
    v_mov_b32 v5, v185
    v_lshrrev_b32 v3, 4, v1
    v_and_b32 v2, 15, v1
    v_mul_u32_u24 v6, 1152, v3
    v_lshl_add_u32 v6, v2, 3, v6
    v_lshrrev_b32 v4, 4, v0
    v_mul_u32_u24 v4, 272, v4
    v_lshl_add_u32 v4, v2, 4, v4
    v_bfe_u32 v21, v1, 2, 2
    v_lshl_add_u32 v22, v3, 3, v21
    v_lshlrev_b32 v22, 7, v22
    v_and_b32 v21, 3, v1
    v_lshl_add_u32 v22, v21, 3, v22
    v_lshlrev_b32 v20, 7, v21
    v_bfe_u32 v21, v1, 2, 1
    v_lshl_add_u32 v20, v21, 11, v20
    v_bfe_u32 v21, v1, 3, 2
    v_lshl_add_u32 v22, v21, 5, v22
    v_xor_b32 v21, 0, v22
    v_add_u32 v8, s43, v21
    v_add_u32 v12, s93, v21
    v_xor_b32 v21, 32, v22
    v_add_u32 v9, s43, v21
    v_add_u32 v13, s93, v21
    v_xor_b32 v21, 64, v22
    v_add_u32 v10, s43, v21
    v_add_u32 v14, s93, v21
    v_xor_b32 v21, 96, v22
    v_add_u32 v11, s43, v21
    v_add_u32 v15, s93, v21
    v_mul_u32_u24 v2, 272, v2
    v_and_b32 v3, 48, v1
    v_add3_u32 v2, v2, v3, s43
    v_and_b32 v3, 7, v1
    v_lshrrev_b32 v22, 3, v1
    v_mul_u32_u24 v22, 1152, v22
    v_bfe_u32 v21, v1, 4, 1
    v_lshlrev_b32 v21, 1, v21
    v_xor_b32 v21, v21, v3
    v_lshl_add_u32 v16, v21, 4, v22
    v_xor_b32 v17, 64, v16
    v_lshrrev_b32 v18, 5, v1
    v_mul_u32_u24 v18, 36864, v18
    v_add_u32 v18, v18, v16
    v_xor_b32 v19, 64, v18
    s_lshl_b32 s32, s45, 2
    s_add_u32 s32, s32, 151584
    v_mov_b32 v168, s32
    v_lshlrev_b32 v7, 7, v1
    s_lshl_b32 s39, s41, 3
    s_cmp_eq_u32 s39, 8192
    s_cselect_b32 s39, s90, s39
    s_setprio 0
L_wo_wait:
    ds_read_b32 v3, v168
    s_waitcnt lgkmcnt(0)
    v_readfirstlane_b32 s32, v3
    s_cmp_lg_u32 s32, 0
    s_cbranch_scc1 L_wo_ok
    s_sleep 1
    s_branch L_wo_wait
L_wo_ok:
    ds_read_b64_tr_b16 v[64:65], v8 offset:20992
    ds_read_b64_tr_b16 v[66:67], v8 offset:21504
    ds_read_b64_tr_b16 v[68:69], v9 offset:20992
    ds_read_b64_tr_b16 v[70:71], v9 offset:21504
    ds_read_b64_tr_b16 v[72:73], v10 offset:20992
    ds_read_b64_tr_b16 v[74:75], v10 offset:21504
    ds_read_b64_tr_b16 v[76:77], v11 offset:20992
    ds_read_b64_tr_b16 v[78:79], v11 offset:21504
    ds_read_b64_tr_b16 v[80:81], v8 offset:25088
    ds_read_b64_tr_b16 v[82:83], v8 offset:25600
    ds_read_b64_tr_b16 v[84:85], v9 offset:25088
    ds_read_b64_tr_b16 v[86:87], v9 offset:25600
    ds_read_b64_tr_b16 v[88:89], v10 offset:25088
    ds_read_b64_tr_b16 v[90:91], v10 offset:25600
    ds_read_b64_tr_b16 v[92:93], v11 offset:25088
    ds_read_b64_tr_b16 v[94:95], v11 offset:25600
    s_waitcnt lgkmcnt(8)
    s_add_u32 m0, s43, 20992
    s_add_u32 s32, s73, 165888
    buffer_load_dwordx4 v16, s[52:55], s32 offen lds
    s_add_u32 m0, m0, 1024
    s_add_u32 s32, s73, 175104
    buffer_load_dwordx4 v17, s[52:55], s32 offen lds
    s_add_u32 m0, m0, 1024
    s_add_u32 s32, s73, 188928
    buffer_load_dwordx4 v16, s[52:55], s32 offen lds
    s_add_u32 m0, m0, 1024
    s_add_u32 s32, s73, 198144
    buffer_load_dwordx4 v17, s[52:55], s32 offen lds
    ds_read_b64_tr_b16 v[96:97], v12 offset:0
    ds_read_b64_tr_b16 v[98:99], v12 offset:512
    ds_read_b64_tr_b16 v[100:101], v13 offset:0
    ds_read_b64_tr_b16 v[102:103], v13 offset:512
    ds_read_b64_tr_b16 v[104:105], v14 offset:0
    ds_read_b64_tr_b16 v[106:107], v14 offset:512
    ds_read_b64_tr_b16 v[108:109], v15 offset:0
    ds_read_b64_tr_b16 v[110:111], v15 offset:512
    s_waitcnt lgkmcnt(8)
    s_add_u32 m0, s43, 25088
    s_add_u32 s32, s73, 207360
    buffer_load_dwordx4 v16, s[52:55], s32 offen lds
    s_add_u32 m0, m0, 1024
    s_add_u32 s32, s73, 216576
    buffer_load_dwordx4 v17, s[52:55], s32 offen lds
    s_add_u32 m0, m0, 1024
    s_add_u32 s32, s73, 230400
    buffer_load_dwordx4 v16, s[52:55], s32 offen lds
    s_add_u32 m0, m0, 1024
    s_add_u32 s32, s73, 239616
    buffer_load_dwordx4 v17, s[52:55], s32 offen lds
    s_waitcnt vmcnt(8)
    s_mov_b64 exec, 1
    ds_add_rtn_u32 v3, v160, v161 offset:4
    v_mov_b32 v22, s23
    s_waitcnt lgkmcnt(0)
    v_and_b32 v3, 3, v3
    v_xor_b32 v3, 3, v3
    v_lshlrev_b32 v3, 28, v3
    buffer_store_dword v22, v3, s[12:15], s71 offen sc1
    s_mov_b64 exec, -1
    s_cmp_eq_u32 s42, 0
    s_cbranch_scc1 L_end
    ds_read_b64_tr_b16 v[112:113], v12 offset:4096
    ds_read_b64_tr_b16 v[114:115], v12 offset:4608
    ds_read_b64_tr_b16 v[116:117], v13 offset:4096
    ds_read_b64_tr_b16 v[118:119], v13 offset:4608
    ds_read_b64_tr_b16 v[120:121], v14 offset:4096
    ds_read_b64_tr_b16 v[122:123], v14 offset:4608
    ds_read_b64_tr_b16 v[124:125], v15 offset:4096
    ds_read_b64_tr_b16 v[126:127], v15 offset:4608
    s_waitcnt lgkmcnt(8)
    s_add_u32 m0, s93, 0
    s_add_u32 s32, s73, 248832
    buffer_load_dwordx4 v16, s[52:55], s32 offen lds
    s_add_u32 m0, m0, 1024
    s_add_u32 s32, s73, 258048
    buffer_load_dwordx4 v17, s[52:55], s32 offen lds
    s_add_u32 m0, m0, 1024
    s_add_u32 s32, s73, 271872
    buffer_load_dwordx4 v16, s[52:55], s32 offen lds
    s_add_u32 m0, m0, 1024
    s_add_u32 s32, s73, 281088
    buffer_load_dwordx4 v17, s[52:55], s32 offen lds
    s_waitcnt lgkmcnt(0)
    s_add_u32 m0, s93, 4096
    s_add_u32 s32, s73, 290304
    buffer_load_dwordx4 v16, s[52:55], s32 offen lds
    s_add_u32 m0, m0, 1024
    s_add_u32 s32, s73, 299520
    buffer_load_dwordx4 v17, s[52:55], s32 offen lds
    s_add_u32 m0, m0, 1024
    s_add_u32 s32, s73, 313344
    buffer_load_dwordx4 v16, s[52:55], s32 offen lds
    s_add_u32 m0, m0, 1024
    s_add_u32 s32, s73, 322560
    buffer_load_dwordx4 v17, s[52:55], s32 offen lds
    s_waitcnt vmcnt(13)
    ds_read_b64_tr_b16 v[128:129], v8 offset:20992
    ds_read_b64_tr_b16 v[130:131], v8 offset:21504
    ds_read_b64_tr_b16 v[132:133], v9 offset:20992
    ds_read_b64_tr_b16 v[134:135], v9 offset:21504
    ds_read_b64_tr_b16 v[136:137], v10 offset:20992
    ds_read_b64_tr_b16 v[138:139], v10 offset:21504
    ds_read_b64_tr_b16 v[140:141], v11 offset:20992
    ds_read_b64_tr_b16 v[142:143], v11 offset:21504
    s_waitcnt vmcnt(9)
    ds_read_b64_tr_b16 v[144:145], v8 offset:25088
    ds_read_b64_tr_b16 v[146:147], v8 offset:25600
    ds_read_b64_tr_b16 v[148:149], v9 offset:25088
    ds_read_b64_tr_b16 v[150:151], v9 offset:25600
    ds_read_b64_tr_b16 v[152:153], v10 offset:25088
    ds_read_b64_tr_b16 v[154:155], v10 offset:25600
    ds_read_b64_tr_b16 v[156:157], v11 offset:25088
    ds_read_b64_tr_b16 v[158:159], v11 offset:25600
    s_waitcnt lgkmcnt(8)
    s_add_u32 m0, s43, 20992
    s_add_u32 s32, s73, 18432
    buffer_load_dwordx4 v18, s[52:55], s32 offen lds
    s_add_u32 m0, m0, 1024
    s_add_u32 s32, s73, 101376
    buffer_load_dwordx4 v19, s[52:55], s32 offen lds
    s_add_u32 m0, m0, 1024
    s_add_u32 s32, s73, 184320
    buffer_load_dwordx4 v18, s[52:55], s32 offen lds
    s_add_u32 m0, m0, 1024
    s_add_u32 s32, s73, 267264
    buffer_load_dwordx4 v19, s[52:55], s32 offen lds
    s_mov_b32 exec_lo, s65
    s_mov_b32 exec_hi, 0
    buffer_load_dword v21, v20, s[12:15], s64 offen sc1
    s_mov_b64 exec, -1
    s_waitcnt vmcnt(9)
    ds_read_b64_tr_b16 v[160:161], v12 offset:0
    ds_read_b64_tr_b16 v[162:163], v12 offset:512
    ds_read_b64_tr_b16 v[164:165], v13 offset:0
    ds_read_b64_tr_b16 v[166:167], v13 offset:512
    ds_read_b64_tr_b16 v[168:169], v14 offset:0
    ds_read_b64_tr_b16 v[170:171], v14 offset:512
    ds_read_b64_tr_b16 v[172:173], v15 offset:0
    ds_read_b64_tr_b16 v[174:175], v15 offset:512
    s_waitcnt vmcnt(5)
    ds_read_b64_tr_b16 v[176:177], v12 offset:4096
    ds_read_b64_tr_b16 v[178:179], v12 offset:4608
    ds_read_b64_tr_b16 v[180:181], v13 offset:4096
    ds_read_b64_tr_b16 v[182:183], v13 offset:4608
    ds_read_b64_tr_b16 v[184:185], v14 offset:4096
    ds_read_b64_tr_b16 v[186:187], v14 offset:4608
    ds_read_b64_tr_b16 v[188:189], v15 offset:4096
    ds_read_b64_tr_b16 v[190:191], v15 offset:4608
    s_waitcnt vmcnt(1)
    ds_read_b64_tr_b16 v[192:193], v8 offset:20992
    ds_read_b64_tr_b16 v[194:195], v8 offset:21504
    ds_read_b64_tr_b16 v[196:197], v9 offset:20992
    ds_read_b64_tr_b16 v[198:199], v9 offset:21504
    ds_read_b64_tr_b16 v[200:201], v10 offset:20992
    ds_read_b64_tr_b16 v[202:203], v10 offset:21504
    ds_read_b64_tr_b16 v[204:205], v11 offset:20992
    ds_read_b64_tr_b16 v[206:207], v11 offset:21504
    s_setprio 0
    s_waitcnt vmcnt(0)
    s_mov_b32 exec_lo, s65
    s_mov_b32 exec_hi, 0
    v_cmp_ne_u32 vcc, s23, v21
    s_cbranch_vccz L_e_ok
L_e_poll:
    buffer_load_dword v21, v20, s[12:15], s64 offen sc1
    s_waitcnt vmcnt(0)
    v_cmp_ne_u32 vcc, s23, v21
    s_cbranch_vccz L_e_ok
    s_sub_u32 s99, s99, 1
    s_cbranch_scc1 L_e_ok
    s_sleep 1
    s_branch L_e_poll
L_e_ok:
    s_mov_b64 exec, -1
    s_cmp_lt_u32 s40, 16
    s_cbranch_scc1 L_e3
    buffer_load_dwordx4 v[244:247], v5, s[48:51], s85 offen offset:0 sc1
    buffer_load_dwordx4 v[248:251], v5, s[48:51], s85 offen offset:1024 sc1
    buffer_load_dwordx4 v[252:255], v5, s[48:51], s85 offen offset:2048 sc1
    buffer_load_dwordx4 v[24:27], v5, s[48:51], s85 offen offset:3072 sc1
    s_add_u32 s32, s85, 4096
    buffer_load_dwordx4 v[28:31], v5, s[48:51], s32 offen offset:0 sc1
    buffer_load_dwordx4 v[32:35], v5, s[48:51], s32 offen offset:1024 sc1
    buffer_load_dwordx4 v[36:39], v5, s[48:51], s32 offen offset:2048 sc1
    s_waitcnt lgkmcnt(0)
    s_branch L_e2
L_e3:
    buffer_load_dwordx4 v[208:211], v5, s[48:51], s84 offen offset:0 sc1
    buffer_load_dwordx4 v[212:215], v5, s[48:51], s84 offen offset:1024 sc1
    buffer_load_dwordx4 v[216:219], v5, s[48:51], s84 offen offset:2048 sc1
    buffer_load_dwordx4 v[220:223], v5, s[48:51], s84 offen offset:3072 sc1
    s_add_u32 s32, s84, 4096
    buffer_load_dwordx4 v[224:227], v5, s[48:51], s32 offen offset:0 sc1
    buffer_load_dwordx4 v[228:231], v5, s[48:51], s32 offen offset:1024 sc1
    buffer_load_dwordx4 v[232:235], v5, s[48:51], s32 offen offset:2048 sc1
    s_waitcnt lgkmcnt(0)
    s_waitcnt vmcnt(6)
    v_mfma_f32_16x16x32_bf16 v[48:51], v[64:67], v[208:211], 0
    v_mfma_f32_16x16x32_bf16 v[52:55], v[68:71], v[208:211], 0
    v_mfma_f32_16x16x32_bf16 v[56:59], v[72:75], v[208:211], 0
    v_mfma_f32_16x16x32_bf16 v[60:63], v[76:79], v[208:211], 0
    buffer_load_dwordx4 v[236:239], v5, s[48:51], s32 offen offset:3072 sc1
    s_waitcnt vmcnt(6)
    v_mfma_f32_16x16x32_bf16 v[48:51], v[80:83], v[212:215], v[48:51]
    v_mfma_f32_16x16x32_bf16 v[52:55], v[84:87], v[212:215], v[52:55]
    v_mfma_f32_16x16x32_bf16 v[56:59], v[88:91], v[212:215], v[56:59]
    v_mfma_f32_16x16x32_bf16 v[60:63], v[92:95], v[212:215], v[60:63]
    s_add_u32 s32, s84, s90
    buffer_load_dwordx4 v[240:243], v5, s[48:51], s32 offen offset:0 sc1
    s_waitcnt vmcnt(6)
    v_mfma_f32_16x16x32_bf16 v[48:51], v[96:99], v[216:219], v[48:51]
    v_mfma_f32_16x16x32_bf16 v[52:55], v[100:103], v[216:219], v[52:55]
    v_mfma_f32_16x16x32_bf16 v[56:59], v[104:107], v[216:219], v[56:59]
    v_mfma_f32_16x16x32_bf16 v[60:63], v[108:111], v[216:219], v[60:63]
    buffer_load_dwordx4 v[244:247], v5, s[48:51], s85 offen offset:0 sc1
    s_waitcnt vmcnt(6)
    v_mfma_f32_16x16x32_bf16 v[48:51], v[112:115], v[220:223], v[48:51]
    v_mfma_f32_16x16x32_bf16 v[52:55], v[116:119], v[220:223], v[52:55]
    v_mfma_f32_16x16x32_bf16 v[56:59], v[120:123], v[220:223], v[56:59]
    v_mfma_f32_16x16x32_bf16 v[60:63], v[124:127], v[220:223], v[60:63]
    buffer_load_dwordx4 v[248:251], v5, s[48:51], s85 offen offset:1024 sc1
    s_waitcnt vmcnt(6)
    v_mfma_f32_16x16x32_bf16 v[48:51], v[128:131], v[224:227], v[48:51]
    v_mfma_f32_16x16x32_bf16 v[52:55], v[132:135], v[224:227], v[52:55]
    v_mfma_f32_16x16x32_bf16 v[56:59], v[136:139], v[224:227], v[56:59]
    v_mfma_f32_16x16x32_bf16 v[60:63], v[140:143], v[224:227], v[60:63]
    buffer_load_dwordx4 v[252:255], v5, s[48:51], s85 offen offset:2048 sc1
    s_waitcnt vmcnt(6)
    v_mfma_f32_16x16x32_bf16 v[48:51], v[144:147], v[228:231], v[48:51]
    v_mfma_f32_16x16x32_bf16 v[52:55], v[148:151], v[228:231], v[52:55]
    v_mfma_f32_16x16x32_bf16 v[56:59], v[152:155], v[228:231], v[56:59]
    v_mfma_f32_16x16x32_bf16 v[60:63], v[156:159], v[228:231], v[60:63]
    buffer_load_dwordx4 v[24:27], v5, s[48:51], s85 offen offset:3072 sc1
    s_waitcnt vmcnt(6)
    v_mfma_f32_16x16x32_bf16 v[48:51], v[160:163], v[232:235], v[48:51]
    v_mfma_f32_16x16x32_bf16 v[52:55], v[164:167], v[232:235], v[52:55]
    v_mfma_f32_16x16x32_bf16 v[56:59], v[168:171], v[232:235], v[56:59]
    v_mfma_f32_16x16x32_bf16 v[60:63], v[172:175], v[232:235], v[60:63]
    s_add_u32 s32, s85, 4096
    buffer_load_dwordx4 v[28:31], v5, s[48:51], s32 offen offset:0 sc1
    s_waitcnt vmcnt(6)
    v_mfma_f32_16x16x32_bf16 v[48:51], v[176:179], v[236:239], v[48:51]
    v_mfma_f32_16x16x32_bf16 v[52:55], v[180:183], v[236:239], v[52:55]
    v_mfma_f32_16x16x32_bf16 v[56:59], v[184:187], v[236:239], v[56:59]
    v_mfma_f32_16x16x32_bf16 v[60:63], v[188:191], v[236:239], v[60:63]
    buffer_load_dwordx4 v[32:35], v5, s[48:51], s32 offen offset:1024 sc1
    s_waitcnt vmcnt(6)
    v_mfma_f32_16x16x32_bf16 v[48:51], v[192:195], v[240:243], v[48:51]
    v_mfma_f32_16x16x32_bf16 v[52:55], v[196:199], v[240:243], v[52:55]
    v_mfma_f32_16x16x32_bf16 v[56:59], v[200:203], v[240:243], v[56:59]
    v_mfma_f32_16x16x32_bf16 v[60:63], v[204:207], v[240:243], v[60:63]
    buffer_load_dwordx4 v[36:39], v5, s[48:51], s32 offen offset:2048 sc1
    v_add_u32 v3, s76, v2
    s_nop 3
    ds_write_b128 v3, v[48:51] offset:0
    ds_write_b128 v3, v[52:55] offset:64
    ds_write_b128 v3, v[56:59] offset:128
    ds_write_b128 v3, v[60:63] offset:192
L_e2:
    s_waitcnt vmcnt(6)
    v_mfma_f32_16x16x32_bf16 v[48:51], v[64:67], v[244:247], 0
    v_mfma_f32_16x16x32_bf16 v[52:55], v[68:71], v[244:247], 0
    v_mfma_f32_16x16x32_bf16 v[56:59], v[72:75], v[244:247], 0
    v_mfma_f32_16x16x32_bf16 v[60:63], v[76:79], v[244:247], 0
    buffer_load_dwordx4 v[40:43], v5, s[48:51], s32 offen offset:3072 sc1
    s_waitcnt vmcnt(6)
    v_mfma_f32_16x16x32_bf16 v[48:51], v[80:83], v[248:251], v[48:51]
    v_mfma_f32_16x16x32_bf16 v[52:55], v[84:87], v[248:251], v[52:55]
    v_mfma_f32_16x16x32_bf16 v[56:59], v[88:91], v[248:251], v[56:59]
    v_mfma_f32_16x16x32_bf16 v[60:63], v[92:95], v[248:251], v[60:63]
    s_add_u32 s32, s85, s90
    buffer_load_dwordx4 v[44:47], v5, s[48:51], s32 offen offset:0 sc1
    s_waitcnt vmcnt(6)
    v_mfma_f32_16x16x32_bf16 v[48:51], v[96:99], v[252:255], v[48:51]
    v_mfma_f32_16x16x32_bf16 v[52:55], v[100:103], v[252:255], v[52:55]
    v_mfma_f32_16x16x32_bf16 v[56:59], v[104:107], v[252:255], v[56:59]
    v_mfma_f32_16x16x32_bf16 v[60:63], v[108:111], v[252:255], v[60:63]
    buffer_load_dwordx4 v[208:211], v5, s[48:51], s86 offen offset:0 sc1
    s_waitcnt vmcnt(6)
    v_mfma_f32_16x16x32_bf16 v[48:51], v[112:115], v[24:27], v[48:51]
    v_mfma_f32_16x16x32_bf16 v[52:55], v[116:119], v[24:27], v[52:55]
    v_mfma_f32_16x16x32_bf16 v[56:59], v[120:123], v[24:27], v[56:59]
    v_mfma_f32_16x16x32_bf16 v[60:63], v[124:127], v[24:27], v[60:63]
    buffer_load_dwordx4 v[212:215], v5, s[48:51], s86 offen offset:1024 sc1
    s_waitcnt vmcnt(6)
    v_mfma_f32_16x16x32_bf16 v[48:51], v[128:131], v[28:31], v[48:51]
    v_mfma_f32_16x16x32_bf16 v[52:55], v[132:135], v[28:31], v[52:55]
    v_mfma_f32_16x16x32_bf16 v[56:59], v[136:139], v[28:31], v[56:59]
    v_mfma_f32_16x16x32_bf16 v[60:63], v[140:143], v[28:31], v[60:63]
    buffer_load_dwordx4 v[216:219], v5, s[48:51], s86 offen offset:2048 sc1
    s_waitcnt vmcnt(6)
    v_mfma_f32_16x16x32_bf16 v[48:51], v[144:147], v[32:35], v[48:51]
    v_mfma_f32_16x16x32_bf16 v[52:55], v[148:151], v[32:35], v[52:55]
    v_mfma_f32_16x16x32_bf16 v[56:59], v[152:155], v[32:35], v[56:59]
    v_mfma_f32_16x16x32_bf16 v[60:63], v[156:159], v[32:35], v[60:63]
    buffer_load_dwordx4 v[220:223], v5, s[48:51], s86 offen offset:3072 sc1
    s_waitcnt vmcnt(6)
    v_mfma_f32_16x16x32_bf16 v[48:51], v[160:163], v[36:39], v[48:51]
    v_mfma_f32_16x16x32_bf16 v[52:55], v[164:167], v[36:39], v[52:55]
    v_mfma_f32_16x16x32_bf16 v[56:59], v[168:171], v[36:39], v[56:59]
    v_mfma_f32_16x16x32_bf16 v[60:63], v[172:175], v[36:39], v[60:63]
    s_add_u32 s32, s86, 4096
    buffer_load_dwordx4 v[224:227], v5, s[48:51], s32 offen offset:0 sc1
    s_waitcnt vmcnt(6)
    v_mfma_f32_16x16x32_bf16 v[48:51], v[176:179], v[40:43], v[48:51]
    v_mfma_f32_16x16x32_bf16 v[52:55], v[180:183], v[40:43], v[52:55]
    v_mfma_f32_16x16x32_bf16 v[56:59], v[184:187], v[40:43], v[56:59]
    v_mfma_f32_16x16x32_bf16 v[60:63], v[188:191], v[40:43], v[60:63]
    buffer_load_dwordx4 v[228:231], v5, s[48:51], s32 offen offset:1024 sc1
    s_waitcnt vmcnt(6)
    v_mfma_f32_16x16x32_bf16 v[48:51], v[192:195], v[44:47], v[48:51]
    v_mfma_f32_16x16x32_bf16 v[52:55], v[196:199], v[44:47], v[52:55]
    v_mfma_f32_16x16x32_bf16 v[56:59], v[200:203], v[44:47], v[56:59]
    v_mfma_f32_16x16x32_bf16 v[60:63], v[204:207], v[44:47], v[60:63]
    buffer_load_dwordx4 v[232:235], v5, s[48:51], s32 offen offset:2048 sc1
    v_add_u32 v3, s77, v2
    s_nop 3
    ds_write_b128 v3, v[48:51] offset:0
    ds_write_b128 v3, v[52:55] offset:64
    ds_write_b128 v3, v[56:59] offset:128
    ds_write_b128 v3, v[60:63] offset:192
    s_waitcnt vmcnt(6)
    v_mfma_f32_16x16x32_bf16 v[48:51], v[64:67], v[208:211], 0
    v_mfma_f32_16x16x32_bf16 v[52:55], v[68:71], v[208:211], 0
    v_mfma_f32_16x16x32_bf16 v[56:59], v[72:75], v[208:211], 0
    v_mfma_f32_16x16x32_bf16 v[60:63], v[76:79], v[208:211], 0
    buffer_load_dwordx4 v[236:239], v5, s[48:51], s32 offen offset:3072 sc1
    s_waitcnt vmcnt(6)
    v_mfma_f32_16x16x32_bf16 v[48:51], v[80:83], v[212:215], v[48:51]
    v_mfma_f32_16x16x32_bf16 v[52:55], v[84:87], v[212:215], v[52:55]
    v_mfma_f32_16x16x32_bf16 v[56:59], v[88:91], v[212:215], v[56:59]
    v_mfma_f32_16x16x32_bf16 v[60:63], v[92:95], v[212:215], v[60:63]
    s_add_u32 s32, s86, s90
    buffer_load_dwordx4 v[240:243], v5, s[48:51], s32 offen offset:0 sc1
    s_mov_b64 exec, 15
    buffer_load_dword v21, v20, s[12:15], s66 offen sc1
    s_mov_b64 exec, -1
    s_waitcnt vmcnt(7)
    v_mfma_f32_16x16x32_bf16 v[48:51], v[96:99], v[216:219], v[48:51]
    v_mfma_f32_16x16x32_bf16 v[52:55], v[100:103], v[216:219], v[52:55]
    v_mfma_f32_16x16x32_bf16 v[56:59], v[104:107], v[216:219], v[56:59]
    v_mfma_f32_16x16x32_bf16 v[60:63], v[108:111], v[216:219], v[60:63]
    s_waitcnt vmcnt(6)
    v_mfma_f32_16x16x32_bf16 v[48:51], v[112:115], v[220:223], v[48:51]
    v_mfma_f32_16x16x32_bf16 v[52:55], v[116:119], v[220:223], v[52:55]
    v_mfma_f32_16x16x32_bf16 v[56:59], v[120:123], v[220:223], v[56:59]
    v_mfma_f32_16x16x32_bf16 v[60:63], v[124:127], v[220:223], v[60:63]
    s_waitcnt vmcnt(5)
    v_mfma_f32_16x16x32_bf16 v[48:51], v[128:131], v[224:227], v[48:51]
    v_mfma_f32_16x16x32_bf16 v[52:55], v[132:135], v[224:227], v[52:55]
    v_mfma_f32_16x16x32_bf16 v[56:59], v[136:139], v[224:227], v[56:59]
    v_mfma_f32_16x16x32_bf16 v[60:63], v[140:143], v[224:227], v[60:63]
    s_waitcnt vmcnt(4)
    v_mfma_f32_16x16x32_bf16 v[48:51], v[144:147], v[228:231], v[48:51]
    v_mfma_f32_16x16x32_bf16 v[52:55], v[148:151], v[228:231], v[52:55]
    v_mfma_f32_16x16x32_bf16 v[56:59], v[152:155], v[228:231], v[56:59]
    v_mfma_f32_16x16x32_bf16 v[60:63], v[156:159], v[228:231], v[60:63]
    s_waitcnt vmcnt(0)
    s_mov_b64 exec, 15
    v_cmp_ne_u32 vcc, s23, v21
    s_mov_b64 exec, -1
    s_cbranch_vccnz L_late_slow
    buffer_load_dwordx4 v[244:247], v5, s[48:51], s87 offen offset:0 sc1
    buffer_load_dwordx4 v[248:251], v5, s[48:51], s87 offen offset:1024 sc1
    buffer_load_dwordx4 v[252:255], v5, s[48:51], s87 offen offset:2048 sc1
    v_mfma_f32_16x16x32_bf16 v[48:51], v[160:163], v[232:235], v[48:51]
    v_mfma_f32_16x16x32_bf16 v[52:55], v[164:167], v[232:235], v[52:55]
    v_mfma_f32_16x16x32_bf16 v[56:59], v[168:171], v[232:235], v[56:59]
    v_mfma_f32_16x16x32_bf16 v[60:63], v[172:175], v[232:235], v[60:63]
    buffer_load_dwordx4 v[24:27], v5, s[48:51], s87 offen offset:3072 sc1
    s_add_u32 s32, s87, 4096
    buffer_load_dwordx4 v[28:31], v5, s[48:51], s32 offen offset:0 sc1
    buffer_load_dwordx4 v[32:35], v5, s[48:51], s32 offen offset:1024 sc1
    v_mfma_f32_16x16x32_bf16 v[48:51], v[176:179], v[236:239], v[48:51]
    v_mfma_f32_16x16x32_bf16 v[52:55], v[180:183], v[236:239], v[52:55]
    v_mfma_f32_16x16x32_bf16 v[56:59], v[184:187], v[236:239], v[56:59]
    v_mfma_f32_16x16x32_bf16 v[60:63], v[188:191], v[236:239], v[60:63]
    buffer_load_dwordx4 v[36:39], v5, s[48:51], s32 offen offset:2048 sc1
    buffer_load_dwordx4 v[40:43], v5, s[48:51], s32 offen offset:3072 sc1
    s_add_u32 s32, s87, s90
    buffer_load_dwordx4 v[44:47], v5, s[48:51], s32 offen offset:0 sc1
    v_mfma_f32_16x16x32_bf16 v[48:51], v[192:195], v[240:243], v[48:51]
    v_mfma_f32_16x16x32_bf16 v[52:55], v[196:199], v[240:243], v[52:55]
    v_mfma_f32_16x16x32_bf16 v[56:59], v[200:203], v[240:243], v[56:59]
    v_mfma_f32_16x16x32_bf16 v[60:63], v[204:207], v[240:243], v[60:63]
    v_add_u32 v3, s92, v2
    s_nop 3
    ds_write_b128 v3, v[48:51] offset:0
    ds_write_b128 v3, v[52:55] offset:64
    ds_write_b128 v3, v[56:59] offset:128
    ds_write_b128 v3, v[60:63] offset:192
    s_branch L_late_go
L_late_slow:
    s_mov_b64 exec, 15
    buffer_load_dword v21, v20, s[12:15], s66 offen sc1
    s_mov_b64 exec, -1
    v_mfma_f32_16x16x32_bf16 v[48:51], v[160:163], v[232:235], v[48:51]
    v_mfma_f32_16x16x32_bf16 v[52:55], v[164:167], v[232:235], v[52:55]
    v_mfma_f32_16x16x32_bf16 v[56:59], v[168:171], v[232:235], v[56:59]
    v_mfma_f32_16x16x32_bf16 v[60:63], v[172:175], v[232:235], v[60:63]
    v_mfma_f32_16x16x32_bf16 v[48:51], v[176:179], v[236:239], v[48:51]
    v_mfma_f32_16x16x32_bf16 v[52:55], v[180:183], v[236:239], v[52:55]
    v_mfma_f32_16x16x32_bf16 v[56:59], v[184:187], v[236:239], v[56:59]
    v_mfma_f32_16x16x32_bf16 v[60:63], v[188:191], v[236:239], v[60:63]
    v_mfma_f32_16x16x32_bf16 v[48:51], v[192:195], v[240:243], v[48:51]
    v_mfma_f32_16x16x32_bf16 v[52:55], v[196:199], v[240:243], v[52:55]
    v_mfma_f32_16x16x32_bf16 v[56:59], v[200:203], v[240:243], v[56:59]
    v_mfma_f32_16x16x32_bf16 v[60:63], v[204:207], v[240:243], v[60:63]
    v_add_u32 v3, s92, v2
    s_nop 3
    ds_write_b128 v3, v[48:51] offset:0
    ds_write_b128 v3, v[52:55] offset:64
    ds_write_b128 v3, v[56:59] offset:128
    ds_write_b128 v3, v[60:63] offset:192
    s_waitcnt vmcnt(0)
    s_mov_b64 exec, 15
    v_cmp_ne_u32 vcc, s23, v21
    s_cbranch_vccz L_l_ok
L_l_poll:
    buffer_load_dword v21, v20, s[12:15], s66 offen sc1
    s_waitcnt vmcnt(0)
    v_cmp_ne_u32 vcc, s23, v21
    s_cbranch_vccz L_l_ok
    s_sub_u32 s99, s99, 1
    s_cbranch_scc1 L_l_ok
    s_sleep 1
    s_branch L_l_poll
L_l_ok:
    s_mov_b64 exec, -1
    buffer_load_dwordx4 v[244:247], v5, s[48:51], s87 offen offset:0 sc1
    buffer_load_dwordx4 v[248:251], v5, s[48:51], s87 offen offset:1024 sc1
    buffer_load_dwordx4 v[252:255], v5, s[48:51], s87 offen offset:2048 sc1
    buffer_load_dwordx4 v[24:27], v5, s[48:51], s87 offen offset:3072 sc1
    s_add_u32 s32, s87, 4096
    buffer_load_dwordx4 v[28:31], v5, s[48:51], s32 offen offset:0 sc1
    buffer_load_dwordx4 v[32:35], v5, s[48:51], s32 offen offset:1024 sc1
    buffer_load_dwordx4 v[36:39], v5, s[48:51], s32 offen offset:2048 sc1
    buffer_load_dwordx4 v[40:43], v5, s[48:51], s32 offen offset:3072 sc1
    s_add_u32 s32, s87, s90
    buffer_load_dwordx4 v[44:47], v5, s[48:51], s32 offen offset:0 sc1
L_late_go:
    buffer_load_dwordx4 v[208:211], v5, s[48:51], s88 offen offset:0 sc1
    buffer_load_dwordx4 v[212:215], v5, s[48:51], s88 offen offset:1024 sc1
    s_waitcnt vmcnt(10)
    v_mfma_f32_16x16x32_bf16 v[48:51], v[64:67], v[244:247], 0
    v_mfma_f32_16x16x32_bf16 v[52:55], v[68:71], v[244:247], 0
    v_mfma_f32_16x16x32_bf16 v[56:59], v[72:75], v[244:247], 0
    v_mfma_f32_16x16x32_bf16 v[60:63], v[76:79], v[244:247], 0
    buffer_load_dwordx4 v[216:219], v5, s[48:51], s88 offen offset:2048 sc1
    buffer_load_dwordx4 v[220:223], v5, s[48:51], s88 offen offset:3072 sc1
    s_waitcnt vmcnt(11)
    v_mfma_f32_16x16x32_bf16 v[48:51], v[80:83], v[248:251], v[48:51]
    v_mfma_f32_16x16x32_bf16 v[52:55], v[84:87], v[248:251], v[52:55]
    v_mfma_f32_16x16x32_bf16 v[56:59], v[88:91], v[248:251], v[56:59]
    v_mfma_f32_16x16x32_bf16 v[60:63], v[92:95], v[248:251], v[60:63]
    s_add_u32 s32, s88, 4096
    buffer_load_dwordx4 v[224:227], v5, s[48:51], s32 offen offset:0 sc1
    buffer_load_dwordx4 v[228:231], v5, s[48:51], s32 offen offset:1024 sc1
    s_waitcnt vmcnt(12)
    v_mfma_f32_16x16x32_bf16 v[48:51], v[96:99], v[252:255], v[48:51]
    v_mfma_f32_16x16x32_bf16 v[52:55], v[100:103], v[252:255], v[52:55]
    v_mfma_f32_16x16x32_bf16 v[56:59], v[104:107], v[252:255], v[56:59]
    v_mfma_f32_16x16x32_bf16 v[60:63], v[108:111], v[252:255], v[60:63]
    buffer_load_dwordx4 v[232:235], v5, s[48:51], s32 offen offset:2048 sc1
    buffer_load_dwordx4 v[236:239], v5, s[48:51], s32 offen offset:3072 sc1
    s_waitcnt vmcnt(13)
    v_mfma_f32_16x16x32_bf16 v[48:51], v[112:115], v[24:27], v[48:51]
    v_mfma_f32_16x16x32_bf16 v[52:55], v[116:119], v[24:27], v[52:55]
    v_mfma_f32_16x16x32_bf16 v[56:59], v[120:123], v[24:27], v[56:59]
    v_mfma_f32_16x16x32_bf16 v[60:63], v[124:127], v[24:27], v[60:63]
    s_add_u32 s32, s88, s90
    buffer_load_dwordx4 v[240:243], v5, s[48:51], s32 offen offset:0 sc1
    s_waitcnt vmcnt(13)
    v_mfma_f32_16x16x32_bf16 v[48:51], v[128:131], v[28:31], v[48:51]
    v_mfma_f32_16x16x32_bf16 v[52:55], v[132:135], v[28:31], v[52:55]
    v_mfma_f32_16x16x32_bf16 v[56:59], v[136:139], v[28:31], v[56:59]
    v_mfma_f32_16x16x32_bf16 v[60:63], v[140:143], v[28:31], v[60:63]
    s_waitcnt vmcnt(12)
    v_mfma_f32_16x16x32_bf16 v[48:51], v[144:147], v[32:35], v[48:51]
    v_mfma_f32_16x16x32_bf16 v[52:55], v[148:151], v[32:35], v[52:55]
    v_mfma_f32_16x16x32_bf16 v[56:59], v[152:155], v[32:35], v[56:59]
    v_mfma_f32_16x16x32_bf16 v[60:63], v[156:159], v[32:35], v[60:63]
    s_waitcnt vmcnt(11)
    v_mfma_f32_16x16x32_bf16 v[48:51], v[160:163], v[36:39], v[48:51]
    v_mfma_f32_16x16x32_bf16 v[52:55], v[164:167], v[36:39], v[52:55]
    v_mfma_f32_16x16x32_bf16 v[56:59], v[168:171], v[36:39], v[56:59]
    v_mfma_f32_16x16x32_bf16 v[60:63], v[172:175], v[36:39], v[60:63]
    s_waitcnt vmcnt(10)
    v_mfma_f32_16x16x32_bf16 v[48:51], v[176:179], v[40:43], v[48:51]
    v_mfma_f32_16x16x32_bf16 v[52:55], v[180:183], v[40:43], v[52:55]
    v_mfma_f32_16x16x32_bf16 v[56:59], v[184:187], v[40:43], v[56:59]
    v_mfma_f32_16x16x32_bf16 v[60:63], v[188:191], v[40:43], v[60:63]
    s_waitcnt vmcnt(9)
    v_mfma_f32_16x16x32_bf16 v[48:51], v[192:195], v[44:47], v[48:51]
    v_mfma_f32_16x16x32_bf16 v[52:55], v[196:199], v[44:47], v[52:55]
    v_mfma_f32_16x16x32_bf16 v[56:59], v[200:203], v[44:47], v[56:59]
    v_mfma_f32_16x16x32_bf16 v[60:63], v[204:207], v[44:47], v[60:63]
    s_waitcnt lgkmcnt(0)
    s_barrier
    s_xor_b32 s33, s89, 0
    s_mul_i32 s33, s33, 4352
    v_add_u32 v3, s33, v2
    s_nop 1
    ds_write_b128 v3, v[48:51] offset:0
    ds_write_b128 v3, v[52:55] offset:64
    ds_write_b128 v3, v[56:59] offset:128
    ds_write_b128 v3, v[60:63] offset:192
    s_waitcnt vmcnt(8)
    v_mfma_f32_16x16x32_bf16 v[48:51], v[64:67], v[208:211], 0
    v_mfma_f32_16x16x32_bf16 v[52:55], v[68:71], v[208:211], 0
    v_mfma_f32_16x16x32_bf16 v[56:59], v[72:75], v[208:211], 0
    v_mfma_f32_16x16x32_bf16 v[60:63], v[76:79], v[208:211], 0
    s_waitcnt vmcnt(7)
    v_mfma_f32_16x16x32_bf16 v[48:51], v[80:83], v[212:215], v[48:51]
    v_mfma_f32_16x16x32_bf16 v[52:55], v[84:87], v[212:215], v[52:55]
    v_mfma_f32_16x16x32_bf16 v[56:59], v[88:91], v[212:215], v[56:59]
    v_mfma_f32_16x16x32_bf16 v[60:63], v[92:95], v[212:215], v[60:63]
    s_waitcnt vmcnt(6)
    v_mfma_f32_16x16x32_bf16 v[48:51], v[96:99], v[216:219], v[48:51]
    v_mfma_f32_16x16x32_bf16 v[52:55], v[100:103], v[216:219], v[52:55]
    v_mfma_f32_16x16x32_bf16 v[56:59], v[104:107], v[216:219], v[56:59]
    v_mfma_f32_16x16x32_bf16 v[60:63], v[108:111], v[216:219], v[60:63]
    s_waitcnt vmcnt(5)
    v_mfma_f32_16x16x32_bf16 v[48:51], v[112:115], v[220:223], v[48:51]
    v_mfma_f32_16x16x32_bf16 v[52:55], v[116:119], v[220:223], v[52:55]
    v_mfma_f32_16x16x32_bf16 v[56:59], v[120:123], v[220:223], v[56:59]
    v_mfma_f32_16x16x32_bf16 v[60:63], v[124:127], v[220:223], v[60:63]
    s_waitcnt vmcnt(4)
    v_mfma_f32_16x16x32_bf16 v[48:51], v[128:131], v[224:227], v[48:51]
    v_mfma_f32_16x16x32_bf16 v[52:55], v[132:135], v[224:227], v[52:55]
    v_mfma_f32_16x16x32_bf16 v[56:59], v[136:139], v[224:227], v[56:59]
    v_mfma_f32_16x16x32_bf16 v[60:63], v[140:143], v[224:227], v[60:63]
    s_waitcnt vmcnt(3)
    v_mfma_f32_16x16x32_bf16 v[48:51], v[144:147], v[228:231], v[48:51]
    v_mfma_f32_16x16x32_bf16 v[52:55], v[148:151], v[228:231], v[52:55]
    v_mfma_f32_16x16x32_bf16 v[56:59], v[152:155], v[228:231], v[56:59]
    v_mfma_f32_16x16x32_bf16 v[60:63], v[156:159], v[228:231], v[60:63]
    s_waitcnt vmcnt(2)
    v_mfma_f32_16x16x32_bf16 v[48:51], v[160:163], v[232:235], v[48:51]
    v_mfma_f32_16x16x32_bf16 v[52:55], v[164:167], v[232:235], v[52:55]
    v_mfma_f32_16x16x32_bf16 v[56:59], v[168:171], v[232:235], v[56:59]
    v_mfma_f32_16x16x32_bf16 v[60:63], v[172:175], v[232:235], v[60:63]
    s_waitcnt vmcnt(1)
    v_mfma_f32_16x16x32_bf16 v[48:51], v[176:179], v[236:239], v[48:51]
    v_mfma_f32_16x16x32_bf16 v[52:55], v[180:183], v[236:239], v[52:55]
    v_mfma_f32_16x16x32_bf16 v[56:59], v[184:187], v[236:239], v[56:59]
    v_mfma_f32_16x16x32_bf16 v[60:63], v[188:191], v[236:239], v[60:63]
    s_waitcnt vmcnt(0)
    v_mfma_f32_16x16x32_bf16 v[48:51], v[192:195], v[240:243], v[48:51]
    v_mfma_f32_16x16x32_bf16 v[52:55], v[196:199], v[240:243], v[52:55]
    v_mfma_f32_16x16x32_bf16 v[56:59], v[200:203], v[240:243], v[56:59]
    v_mfma_f32_16x16x32_bf16 v[60:63], v[204:207], v[240:243], v[60:63]
    s_xor_b32 s33, s89, 1
    s_mul_i32 s33, s33, 4352
    v_add_u32 v3, s33, v2
    s_nop 1
    ds_write_b128 v3, v[48:51] offset:0
    ds_write_b128 v3, v[52:55] offset:64
    ds_write_b128 v3, v[56:59] offset:128
    ds_write_b128 v3, v[60:63] offset:192
    s_waitcnt lgkmcnt(0)
    s_branch L_op_join
L_op_L:
    s_waitcnt vmcnt(0)
    s_mov_b64 exec, 1
    ds_add_rtn_u32 v3, v160, v161 offset:4
    v_mov_b32 v22, s23
    s_waitcnt lgkmcnt(0)
    v_and_b32 v3, 3, v3
    v_xor_b32 v3, 3, v3
    v_lshlrev_b32 v3, 28, v3
    buffer_store_dword v22, v3, s[12:15], s71 offen sc1
    s_mov_b64 exec, -1
    s_cmp_eq_u32 s42, 0
    s_cbranch_scc1 L_end
    s_barrier
    ds_read_b128 v[32:35], v8 offset:0
    ds_read_b128 v[36:39], v8 offset:16
    ds_read_b128 v[40:43], v8 offset:29184
    ds_read_b128 v[44:47], v8 offset:29200
    ds_read_b128 v[48:51], v9 offset:0
    ds_read_b128 v[52:55], v9 offset:16
    ds_read_b128 v[56:59], v9 offset:29184
    ds_read_b128 v[60:63], v9 offset:29200
    s_waitcnt lgkmcnt(4)
    v_add_f32 v32, v32, v40
    v_add_f32 v33, v33, v41
    v_add_f32 v34, v34, v42
    v_add_f32 v35, v35, v43
    v_add_f32 v36, v36, v44
    v_add_f32 v37, v37, v45
    v_add_f32 v38, v38, v46
    v_add_f32 v39, v39, v47
    s_waitcnt lgkmcnt(0)
    v_add_f32 v48, v48, v56
    v_add_f32 v49, v49, v57
    v_add_f32 v50, v50, v58
    v_add_f32 v51, v51, v59
    v_add_f32 v52, v52, v60
    v_add_f32 v53, v53, v61
    v_add_f32 v54, v54, v62
    v_add_f32 v55, v55, v63
    v_add_f32 v32, v32, v48
    v_add_f32 v33, v33, v49
    v_add_f32 v34, v34, v50
    v_add_f32 v35, v35, v51
    v_add_f32 v36, v36, v52
    v_add_f32 v37, v37, v53
    v_add_f32 v38, v38, v54
    v_add_f32 v39, v39, v55
    v_cvt_pk_bf16_f32 v32, v32, v33
    v_cvt_pk_bf16_f32 v33, v34, v35
    v_cvt_pk_bf16_f32 v34, v36, v37
    v_cvt_pk_bf16_f32 v35, v38, v39
    buffer_store_dwordx4 v[32:35], v10, s[16:19], s67 offen
    s_cmp_ge_u32 s20, 6
    s_cbranch_scc1 L_op_join
    ds_read_b128 v[64:67], v11 offset:0
    ds_read_b128 v[68:71], v11 offset:16
    ds_read_b128 v[72:75], v11 offset:8192
    ds_read_b128 v[76:79], v11 offset:8208
    ds_read_b128 v[80:83], v11 offset:16384
    ds_read_b128 v[84:87], v11 offset:16400
    ds_read_b128 v[88:91], v11 offset:24576
    ds_read_b128 v[92:95], v11 offset:24592
    s_waitcnt lgkmcnt(4)
    v_add_f32 v64, v64, v72
    v_add_f32 v65, v65, v73
    v_add_f32 v66, v66, v74
    v_add_f32 v67, v67, v75
    v_add_f32 v68, v68, v76
    v_add_f32 v69, v69, v77
    v_add_f32 v70, v70, v78
    v_add_f32 v71, v71, v79
    s_waitcnt lgkmcnt(0)
    v_add_f32 v80, v80, v88
    v_add_f32 v81, v81, v89
    v_add_f32 v82, v82, v90
    v_add_f32 v83, v83, v91
    v_add_f32 v84, v84, v92
    v_add_f32 v85, v85, v93
    v_add_f32 v86, v86, v94
    v_add_f32 v87, v87, v95
    v_add_f32 v64, v64, v80
    v_add_f32 v65, v65, v81
    v_add_f32 v66, v66, v82
    v_add_f32 v67, v67, v83
    v_add_f32 v68, v68, v84
    v_add_f32 v69, v69, v85
    v_add_f32 v70, v70, v86
    v_add_f32 v71, v71, v87
    v_cvt_pk_bf16_f32 v64, v64, v65
    v_cvt_pk_bf16_f32 v65, v66, v67
    v_cvt_pk_bf16_f32 v66, v68, v69
    v_cvt_pk_bf16_f32 v67, v70, v71
    buffer_store_dwordx4 v[64:67], v10, s[16:19], s70 offen
L_op_join:
    v_add_u32 v7, 58368, v4
    s_barrier
    ds_read_b128 v[96:99], v4 offset:0
    ds_read_b128 v[100:103], v4 offset:29184
    ds_read_b128 v[104:107], v7 offset:0
    ds_read_b128 v[108:111], v7 offset:29184
    s_waitcnt lgkmcnt(2)
    v_add_f32 v96, v96, v100
    v_add_f32 v97, v97, v101
    v_add_f32 v98, v98, v102
    v_add_f32 v99, v99, v103
    s_waitcnt lgkmcnt(0)
    v_add_f32 v104, v104, v108
    v_add_f32 v105, v105, v109
    v_add_f32 v106, v106, v110
    v_add_f32 v107, v107, v111
    v_add_f32 v96, v96, v104
    v_add_f32 v97, v97, v105
    v_add_f32 v98, v98, v106
    v_add_f32 v99, v99, v107
    v_cvt_pk_bf16_f32 v96, v96, v97
    v_cvt_pk_bf16_f32 v97, v98, v99
    buffer_store_dwordx2 v[96:97], v6, s[16:19], s91 offen
L_end:
L_exit:
    s_endpgm
    .p2align 6
L_hook7_pad:
    s_branch L_hook7_ret
L_hook7:
    s_lshl_b32 s32, s22, 4
    s_add_u32 s32, s32, s21
    s_lshl_b32 s37, s32, 7
    s_add_u32 s37, s37, 25165568
    v_lshrrev_b32 v22, 2, v1
    v_and_b32 v21, 3, v1
    v_lshlrev_b32 v21, 2, v21
    v_lshl_add_u32 v22, v22, 7, v21
    s_mul_i32 s34, s45, 9728
    s_add_u32 s35, s44, s34
    s_cmp_eq_u32 s21, 0
    s_cbranch_scc1 L_halo_go1
    s_cmp_eq_u32 s21, 1
    s_movk_i32 s34, 0xaa
    s_cselect_b32 exec_lo, 0xa0, s34
    s_mov_b32 exec_hi, 0
L_halo1_poll:
    buffer_load_dword v21, v22, s[12:15], s37 offen sc1
    s_waitcnt vmcnt(0)
    v_cmp_ne_u32 vcc, s23, v21
    s_cbranch_vccz L_halo1_ok
    s_sub_u32 s99, s99, 1
    s_cbranch_scc1 L_halo1_ok
    s_sleep 1
    s_branch L_halo1_poll
L_halo1_ok:
    s_mov_b64 exec, -1
L_halo_go1:
    s_cmp_ge_u32 s21, 1
    s_cselect_b32 s50, 268435456, 0
    s_cselect_b32 s36, s35, 77824
    s_add_u32 m0, s43, 14592
    s_sub_u32 s36, s36, 34048
    buffer_load_dwordx4 v185, s[48:51], s36 offen sc1 lds
    s_add_u32 m0, m0, 1024
    s_add_u32 s36, s36, 1024
    buffer_load_dwordx4 v185, s[48:51], s36 offen sc1 lds
    s_add_u32 m0, m0, 1024
    s_add_u32 s36, s36, 1024
    buffer_load_dwordx4 v185, s[48:51], s36 offen sc1 lds
    s_add_u32 m0, m0, 1024
    s_add_u32 s36, s36, 1024
    buffer_load_dwordx4 v185, s[48:51], s36 offen sc1 lds
    s_add_u32 m0, m0, 1024
    s_add_u32 s36, s36, 1024
    s_mov_b32 exec_hi, 0xffff
    buffer_load_dwordx4 v185, s[48:51], s36 offen sc1 lds
    s_mov_b64 exec, -1
    s_cmp_eq_u32 s21, 0
    s_cbranch_scc1 L_halo_go0
    s_cmp_eq_u32 s21, 1
    s_movk_i32 s34, 0x55
    s_cselect_b32 exec_lo, 0x50, s34
    s_mov_b32 exec_hi, 0
L_halo0_poll:
    buffer_load_dword v21, v22, s[12:15], s37 offen sc1
    s_waitcnt vmcnt(0)
    v_cmp_ne_u32 vcc, s23, v21
    s_cbranch_vccz L_halo0_ok
    s_sub_u32 s99, s99, 1
    s_cbranch_scc1 L_halo0_ok
    s_sleep 1
    s_branch L_halo0_poll
L_halo0_ok:
    s_mov_b64 exec, -1
L_halo_go0:
    s_cmp_ge_u32 s21, 1
    s_cselect_b32 s50, 268435456, 0
    s_cselect_b32 s36, s35, 77824
    s_add_u32 m0, s43, 9728
    s_sub_u32 s36, s36, 38912
    buffer_load_dwordx4 v185, s[48:51], s36 offen sc1 lds
    s_add_u32 m0, m0, 1024
    s_add_u32 s36, s36, 1024
    buffer_load_dwordx4 v185, s[48:51], s36 offen sc1 lds
    s_add_u32 m0, m0, 1024
    s_add_u32 s36, s36, 1024
    buffer_load_dwordx4 v185, s[48:51], s36 offen sc1 lds
    s_add_u32 m0, m0, 1024
    s_add_u32 s36, s36, 1024
    buffer_load_dwordx4 v185, s[48:51], s36 offen sc1 lds
    s_add_u32 m0, m0, 1024
    s_add_u32 s36, s36, 1024
    s_mov_b32 exec_hi, 0xffff
    buffer_load_dwordx4 v185, s[48:51], s36 offen sc1 lds
    s_mov_b64 exec, -1
    s_waitcnt vmcnt(5) lgkmcnt(0)
    s_barrier
    s_cmp_ge_u32 s21, 2
    s_cselect_b32 s50, 268435456, 0
    s_cselect_b32 s36, s35, 77824
    s_add_u32 m0, s43, 4864
    s_sub_u32 s36, s36, 72960
    buffer_load_dwordx4 v185, s[48:51], s36 offen sc1 lds
    s_add_u32 m0, m0, 1024
    s_add_u32 s36, s36, 1024
    buffer_load_dwordx4 v185, s[48:51], s36 offen sc1 lds
    s_add_u32 m0, m0, 1024
    s_add_u32 s36, s36, 1024
    buffer_load_dwordx4 v185, s[48:51], s36 offen sc1 lds
    s_add_u32 m0, m0, 1024
    s_add_u32 s36, s36, 1024
    buffer_load_dwordx4 v185, s[48:51], s36 offen sc1 lds
    s_add_u32 m0, m0, 1024
    s_add_u32 s36, s36, 1024
    s_mov_b32 exec_hi, 0xffff
    buffer_load_dwordx4 v185, s[48:51], s36 offen sc1 lds
    s_mov_b64 exec, -1
    s_cmp_eq_u32 s42, 1
    s_cselect_b32 s54, 663552, 0
    s_cmp_ge_u32 s45, 2
    s_cselect_b32 s52, s74, s68
    s_cselect_b32 s53, s75, s69
    s_add_u32 m0, s43, 20992
    s_add_u32 s32, s73, 0
    buffer_load_dwordx4 v16, s[52:55], s32 offen lds
    s_add_u32 m0, m0, 1024
    s_add_u32 s32, s73, 9216
    buffer_load_dwordx4 v17, s[52:55], s32 offen lds
    s_add_u32 m0, m0, 1024
    s_add_u32 s32, s73, 23040
    buffer_load_dwordx4 v16, s[52:55], s32 offen lds
    s_add_u32 m0, m0, 1024
    s_add_u32 s32, s73, 32256
    buffer_load_dwordx4 v17, s[52:55], s32 offen lds
    s_add_u32 m0, s43, 25088
    s_add_u32 s32, s73, 41472
    buffer_load_dwordx4 v16, s[52:55], s32 offen lds
    s_add_u32 m0, m0, 1024
    s_add_u32 s32, s73, 50688
    buffer_load_dwordx4 v17, s[52:55], s32 offen lds
    s_add_u32 m0, m0, 1024
    s_add_u32 s32, s73, 64512
    buffer_load_dwordx4 v16, s[52:55], s32 offen lds
    s_add_u32 m0, m0, 1024
    s_add_u32 s32, s73, 73728
    buffer_load_dwordx4 v17, s[52:55], s32 offen lds
    s_add_u32 m0, s93, 0
    s_add_u32 s32, s73, 82944
    buffer_load_dwordx4 v16, s[52:55], s32 offen lds
    s_add_u32 m0, m0, 1024
    s_add_u32 s32, s73, 92160
    buffer_load_dwordx4 v17, s[52:55], s32 offen lds
    s_add_u32 m0, m0, 1024
    s_add_u32 s32, s73, 105984
    buffer_load_dwordx4 v16, s[52:55], s32 offen lds
    s_add_u32 m0, m0, 1024
    s_add_u32 s32, s73, 115200
    buffer_load_dwordx4 v17, s[52:55], s32 offen lds
    s_waitcnt vmcnt(12)
    s_barrier
    s_add_u32 m0, s93, 4096
    s_add_u32 s32, s73, 124416
    buffer_load_dwordx4 v16, s[52:55], s32 offen lds
    s_add_u32 m0, m0, 1024
    s_add_u32 s32, s73, 133632
    buffer_load_dwordx4 v17, s[52:55], s32 offen lds
    s_add_u32 m0, m0, 1024
    s_add_u32 s32, s73, 147456
    buffer_load_dwordx4 v16, s[52:55], s32 offen lds
    s_add_u32 m0, m0, 1024
    s_add_u32 s32, s73, 156672
    buffer_load_dwordx4 v17, s[52:55], s32 offen lds
    s_cmp_ge_u32 s21, 2
    s_cselect_b32 s50, 268435456, 0
    s_cselect_b32 s36, s35, 77824
    s_add_u32 m0, s43, 0
    s_sub_u32 s36, s36, 77824
    buffer_load_dwordx4 v185, s[48:51], s36 offen sc1 lds
    s_add_u32 m0, m0, 1024
    s_add_u32 s36, s36, 1024
    buffer_load_dwordx4 v185, s[48:51], s36 offen sc1 lds
    s_add_u32 m0, m0, 1024
    s_add_u32 s36, s36, 1024
    buffer_load_dwordx4 v185, s[48:51], s36 offen sc1 lds
    s_add_u32 m0, m0, 1024
    s_add_u32 s36, s36, 1024
    buffer_load_dwordx4 v185, s[48:51], s36 offen sc1 lds
    s_add_u32 m0, m0, 1024
    s_add_u32 s36, s36, 1024
    s_mov_b32 exec_hi, 0xffff
    buffer_load_dwordx4 v185, s[48:51], s36 offen sc1 lds
    s_mov_b64 exec, -1
    s_mov_b32 s54, 663552
    s_lshr_b32 s32, s2, 3
    s_mul_i32 s32, s32, 5248
    s_and_b32 s33, s45, 1
    s_mul_i32 s33, s33, 331776
    s_add_u32 s32, s32, s33
    s_add_u32 s32, s32, 165888
    v_lshlrev_b32 v22, 7, v1
    s_movk_i32 exec_hi, 0x1ff
    buffer_load_dword v249, v22, s[52:55], s32 offen
    s_mov_b64 exec, -1
    s_setprio 0
    s_branch L_hs7
L_exact:
    s_cmp_lg_u32 s24, 0
    s_cbranch_scc1 L_finish_done
    s_mov_b32 s24, 1
    s_waitcnt vmcnt(0) lgkmcnt(0)
    s_mul_i32 s32, s46, 2432
    s_add_u32 s32, s32, s43
    s_mul_i32 s39, s20, 1280
    s_add_u32 s39, s39, 151616
    s_sub_u32 s32, s39, s32
    v_add_u32 v164, s32, v178
    v_add_u32 v165, s32, v179
    v_add_u32 v166, s32, v180
    v_add_u32 v167, s32, v181
    s_lshl_b32 s33, s22, 4
    s_mul_i32 s33, s33, 38912
    s_mul_i32 s34, s45, 9728
    s_add_u32 s33, s33, s34
    s_mov_b32 s26, 0
L_ex_task:
    s_cmp_eq_u32 s26, 0
    s_cbranch_scc0 L_ex_qb
    v_mov_b32 v136, v36
    v_mov_b32 v140, v32
    v_mov_b32 v137, v37
    v_mov_b32 v141, v33
    v_mov_b32 v138, v38
    v_mov_b32 v142, v34
    v_mov_b32 v139, v39
    v_mov_b32 v143, v35
    s_branch L_ex_q
L_ex_qb:
    v_mov_b32 v136, v44
    v_mov_b32 v140, v40
    v_mov_b32 v137, v45
    v_mov_b32 v141, v41
    v_mov_b32 v138, v46
    v_mov_b32 v142, v42
    v_mov_b32 v139, v47
    v_mov_b32 v143, v43
L_ex_q:
    s_lshl_b32 s27, s21, 2
    s_add_u32 s27, s27, s46
    s_add_u32 s27, s27, s26
    v_mov_b32 v62, 0xff800000
    s_mov_b32 s28, 0
    v_mov_b32 v144, 0
    v_mov_b32 v145, 0
    v_mov_b32 v146, 0
    v_mov_b32 v147, 0
    v_mov_b32 v148, 0
    v_mov_b32 v149, 0
    v_mov_b32 v150, 0
    v_mov_b32 v151, 0
    v_mov_b32 v152, 0
    v_mov_b32 v153, 0
    v_mov_b32 v154, 0
    v_mov_b32 v155, 0
    v_mov_b32 v156, 0
    v_mov_b32 v157, 0
    v_mov_b32 v158, 0
    v_mov_b32 v159, 0
L_ex_pass:
    s_sub_u32 s30, s27, 8
    s_max_i32 s29, s30, 0
L_ex_tile:
    s_lshr_b32 s34, s29, 2
    s_mul_i32 s34, s34, 38912
    s_and_b32 s35, s29, 3
    s_mul_i32 s35, s35, 2432
    s_add_u32 s34, s34, s35
    s_add_u32 s34, s34, s33
    s_mov_b32 m0, s39
    buffer_load_dword v48, v186, s[12:15], s34 offen offset:1280 sc1
    buffer_load_dwordx4 v[50:53], v185, s[12:15], s34 offen offset:1408 sc1
    buffer_load_dwordx4 v185, s[12:15], s34 offen sc1 lds
    s_mov_b64 exec, 0xffff
    buffer_load_dwordx4 v185, s[12:15], s34 offen offset:1024 sc1 lds
    s_mov_b64 exec, -1
    s_cmp_eq_u32 s29, s27
    s_cbranch_scc1 L_ex_md
    s_cmp_eq_u32 s29, s30
    s_cbranch_scc1 L_ex_mf
    v_mov_b32 v96, 0
    v_mov_b32 v97, 0
    v_mov_b32 v98, 0
    v_mov_b32 v99, 0
    v_mov_b32 v100, 0
    v_mov_b32 v101, 0
    v_mov_b32 v102, 0
    v_mov_b32 v103, 0
    v_mov_b32 v104, 0
    v_mov_b32 v105, 0
    v_mov_b32 v106, 0
    v_mov_b32 v107, 0
    v_mov_b32 v108, 0
    v_mov_b32 v109, 0
    v_mov_b32 v110, 0
    v_mov_b32 v111, 0
    s_branch L_ex_m
L_ex_md:
    v_mov_b32 v96, v192
    v_mov_b32 v97, v193
    v_mov_b32 v98, v194
    v_mov_b32 v99, v195
    v_mov_b32 v100, v196
    v_mov_b32 v101, v197
    v_mov_b32 v102, v198
    v_mov_b32 v103, v199
    v_mov_b32 v104, v200
    v_mov_b32 v105, v201
    v_mov_b32 v106, v202
    v_mov_b32 v107, v203
    v_mov_b32 v108, v204
    v_mov_b32 v109, v205
    v_mov_b32 v110, v206
    v_mov_b32 v111, v207
    s_branch L_ex_m
L_ex_mf:
    v_mov_b32 v96, v208
    v_mov_b32 v97, v209
    v_mov_b32 v98, v210
    v_mov_b32 v99, v211
    v_mov_b32 v100, v212
    v_mov_b32 v101, v213
    v_mov_b32 v102, v214
    v_mov_b32 v103, v215
    v_mov_b32 v104, v216
    v_mov_b32 v105, v217
    v_mov_b32 v106, v218
    v_mov_b32 v107, v219
    v_mov_b32 v108, v220
    v_mov_b32 v109, v221
    v_mov_b32 v110, v222
    v_mov_b32 v111, v223
L_ex_m:
    s_waitcnt vmcnt(0)
    s_nop 1
    v_mfma_f32_32x32x16_bf16 v[96:111], v[48:51], v[136:139], v[96:111]
    v_mfma_f32_32x32x16_bf16 v[96:111], v[50:53], v[140:143], v[96:111]
    ds_read_b64_tr_b16 v[128:129], v164
    ds_read_b64_tr_b16 v[130:131], v165
    ds_read_b64_tr_b16 v[132:133], v166
    ds_read_b64_tr_b16 v[134:135], v167
    s_nop 7
    s_cmp_eq_u32 s28, 0
    s_cbranch_scc0 L_ex_p2
    v_max3_f32 v62, v96, v97, v62
    v_max3_f32 v62, v98, v99, v62
    v_max3_f32 v62, v100, v101, v62
    v_max3_f32 v62, v102, v103, v62
    v_max3_f32 v62, v104, v105, v62
    v_max3_f32 v62, v106, v107, v62
    v_max3_f32 v62, v108, v109, v62
    v_max3_f32 v62, v110, v111, v62
    s_waitcnt lgkmcnt(0)
    s_branch L_ex_next
L_ex_p2:
    v_sub_f32 v96, v96, v62
    v_sub_f32 v97, v97, v62
    v_sub_f32 v98, v98, v62
    v_sub_f32 v99, v99, v62
    v_sub_f32 v100, v100, v62
    v_sub_f32 v101, v101, v62
    v_sub_f32 v102, v102, v62
    v_sub_f32 v103, v103, v62
    v_sub_f32 v104, v104, v62
    v_sub_f32 v105, v105, v62
    v_sub_f32 v106, v106, v62
    v_sub_f32 v107, v107, v62
    v_sub_f32 v108, v108, v62
    v_sub_f32 v109, v109, v62
    v_sub_f32 v110, v110, v62
    v_sub_f32 v111, v111, v62
    v_exp_f32 v96, v96
    v_exp_f32 v97, v97
    v_exp_f32 v98, v98
    v_exp_f32 v99, v99
    v_exp_f32 v100, v100
    v_exp_f32 v101, v101
    v_exp_f32 v102, v102
    v_exp_f32 v103, v103
    v_exp_f32 v104, v104
    v_exp_f32 v105, v105
    v_exp_f32 v106, v106
    v_exp_f32 v107, v107
    v_exp_f32 v108, v108
    v_exp_f32 v109, v109
    v_exp_f32 v110, v110
    v_exp_f32 v111, v111
    v_cvt_pk_bf16_f32 v24, v96, v97
    v_cvt_pk_bf16_f32 v25, v98, v99
    v_cvt_pk_bf16_f32 v26, v100, v101
    v_cvt_pk_bf16_f32 v27, v102, v103
    v_cvt_pk_bf16_f32 v28, v104, v105
    v_cvt_pk_bf16_f32 v29, v106, v107
    v_cvt_pk_bf16_f32 v30, v108, v109
    v_cvt_pk_bf16_f32 v31, v110, v111
    s_waitcnt lgkmcnt(0)
    s_nop 0
    v_mfma_f32_32x32x16_bf16 v[144:159], v[128:131], v[24:27], v[144:159]
    v_mfma_f32_32x32x16_bf16 v[144:159], v[132:135], v[28:31], v[144:159]
L_ex_next:
    s_add_u32 s29, s29, 1
    s_cmp_le_u32 s29, s27
    s_cbranch_scc1 L_ex_tile
    s_cmp_eq_u32 s28, 1
    s_cbranch_scc1 L_ex_taskdone
    v_mov_b32 v63, v62
    s_nop 1
    v_permlane32_swap_b32 v62, v63
    s_nop 1
    v_max_f32 v62, v62, v63
    s_mov_b32 s28, 1
    s_branch L_ex_pass
L_ex_taskdone:
    s_nop 12
    s_cmp_eq_u32 s26, 0
    s_cbranch_scc0 L_ex_ob
    v_mov_b32 v64, v144
    v_mov_b32 v65, v145
    v_mov_b32 v66, v146
    v_mov_b32 v67, v147
    v_mov_b32 v68, v148
    v_mov_b32 v69, v149
    v_mov_b32 v70, v150
    v_mov_b32 v71, v151
    v_mov_b32 v72, v152
    v_mov_b32 v73, v153
    v_mov_b32 v74, v154
    s_mov_b32 s26, 1
    s_branch L_ex_task
L_ex_ob:
    v_mov_b32 v80, v144
    v_mov_b32 v81, v145
    v_mov_b32 v82, v146
    v_mov_b32 v83, v147
    v_mov_b32 v84, v148
    v_mov_b32 v85, v149
    v_mov_b32 v86, v150
    v_mov_b32 v87, v151
    v_mov_b32 v88, v152
    v_mov_b32 v89, v153
    v_mov_b32 v90, v154
    s_branch L_finish
L_short0:
    s_waitcnt vmcnt(0) lgkmcnt(0)
    s_nop 0
    v_mfma_f32_32x32x16_bf16 v[80:95], v[132:135], v[28:31], v[80:95]
    s_branch L_short_go
L_short1:
    s_waitcnt vmcnt(0) lgkmcnt(0)
    s_nop 0
    v_mfma_f32_32x32x16_bf16 v[80:95], v[140:143], v[28:31], v[80:95]
    s_branch L_short_go
L_short2:
    s_waitcnt vmcnt(0) lgkmcnt(0)
    s_nop 0
    v_mfma_f32_32x32x16_bf16 v[80:95], v[148:151], v[28:31], v[80:95]
L_short_go:
    s_cmp_lt_u32 s20, 4
    s_cbranch_scc1 L_short_c
    ds_write_b32 v168, v161
L_short_c:
    s_cmp_lg_u32 s47, 6
    s_nop 11
    s_cbranch_scc1 L_attn_end
    s_barrier
    s_branch L_attn_end
    s_endpgm
L_job_table:
    .long 0x60504
    .long 0x200d0c07
    .long 0x21140f0e
    .long 0x2171615
    .long 0x31e1d1c
    .long 0x2325241f
    .long 0x242c2726
    .long 0x52f2e2d
    .long 0x6363534
    .long 0x263d3c37
    .long 0x27443f3e
    .long 0x8474645
    .long 0x94e4d4c
    .long 0x2955544f
    .long 0x2a5c5756
    .long 0xb5f5e5d
    .long 0xc806564
    .long 0xc806766
    .long 0xd806d6c
    .long 0xd806f6e
    .long 0xe807574
    .long 0xe807776
    .long 0xf807d7c
    .long 0xf807f7e
    .long 0x10800100
    .long 0x10800302
    .long 0x11800908
    .long 0x11800b0a
    .long 0x800504
L_code_end:
.section .rodata,"a"
.p2align 6
.amdhsa_kernel gated_mix__sliding_block__sliding_block__prompt_kernel
  .amdhsa_next_free_vgpr 256
  .amdhsa_next_free_sgpr 102
  .amdhsa_accum_offset 256
  .amdhsa_group_segment_fixed_size 0
  .amdhsa_kernarg_size 80
  .amdhsa_user_sgpr_count 2
  .amdhsa_user_sgpr_kernarg_segment_ptr 1
  .amdhsa_system_sgpr_workgroup_id_x 1
.end_amdhsa_kernel
```
